```python
import torch

def _softmax(x, axis=-1):
    return torch.softmax(x, dim=axis)
def _gelu(x):
    return torch.nn.functional.gelu(x, approximate="tanh")
def _silu(x):
    return torch.nn.functional.silu(x)
def _sigmoid(x):
    return torch.sigmoid(x)
def _layernorm(x, axis=-1, eps=1e-5):
    m = x.mean(dim=axis, keepdim=True)
    v = x.var(dim=axis, keepdim=True, unbiased=False)
    return (x - m) / torch.sqrt(v + eps)
def _scatter_add(tgt, idx, src, axis=0):
    return tgt.clone().index_add_(axis, idx, src)
def _segment_sum(src, seg, n):
    out = torch.zeros((n,) + src.shape[1:], dtype=src.dtype)
    return out.index_add_(0, seg, src)
def _pad(x, pw):
    flat = tuple(v for pair in reversed(pw) for v in pair)
    return torch.nn.functional.pad(x, flat)

kernel_name = 'concat_heads__mha_block_cached__gqa_block_cached__decode'

def setup_inputs():

    _w = (lambda a: (lambda t: t.to(torch.bfloat16) if t.is_floating_point() else t)(torch.as_tensor(a)))
    def _A_setup():
        B, Sq, D = 2, 1, 512
        H, Sk, Dh = 32, 16384, 128
        return {
            "x": _w((lambda *s: torch.randn(*s, dtype=torch.bfloat16) * 0.8)(B, Sq, D)),
            "k_cache": _w((lambda *s: torch.randn(*s, dtype=torch.bfloat16) * 0.8)(B, H, Sk, Dh)),
            "v_cache": _w((lambda *s: torch.randn(*s, dtype=torch.bfloat16) * 0.05)(B, H, Sk, Dh)),
            "wq": _w((lambda *s: torch.randn(*s, dtype=torch.bfloat16) * 0.8)(D, H * Dh) * (D ** -0.5)),
            "wo": _w((lambda *s: torch.randn(*s, dtype=torch.bfloat16) * 0.05)(H * Dh, D) * ((H * Dh) ** -0.5)),
        }
    _A_in = _A_setup()

    def _B_setup():
        B, Sq, D = 2, 1, 512
        Hq, Hkv, Sk, Dh = 32, 8, 16384, 128
        assert Hq % Hkv == 0, (Hq, Hkv)
        return {
            "x": _w((lambda *s: torch.randn(*s, dtype=torch.bfloat16) * 0.8)(B, Sq, D)),
            "k_cache": _w((lambda *s: torch.randn(*s, dtype=torch.bfloat16) * 0.8)(B, Hkv, Sk, Dh)),
            "v_cache": _w((lambda *s: torch.randn(*s, dtype=torch.bfloat16) * 0.05)(B, Hkv, Sk, Dh)),
            "wq": _w((lambda *s: torch.randn(*s, dtype=torch.bfloat16) * 0.8)(D, Hq * Dh) * (D ** -0.5)),
            "wo": _w((lambda *s: torch.randn(*s, dtype=torch.bfloat16) * 0.05)(Hq * Dh, D) * ((Hq * Dh) ** -0.5)),
        }
    _B_in = _B_setup()

    return {
        "A_x": _A_in["x"],
        "A_k_cache": _A_in["k_cache"],
        "A_v_cache": _A_in["v_cache"],
        "A_wq": _A_in["wq"],
        "A_wo": _A_in["wo"],
        "B_x": _B_in["x"],
        "B_k_cache": _B_in["k_cache"],
        "B_v_cache": _B_in["v_cache"],
        "B_wq": _B_in["wq"],
        "B_wo": _B_in["wo"],
    }

def reference(A_x, A_k_cache, A_v_cache, A_wq, A_wo, B_x, B_k_cache, B_v_cache, B_wq, B_wo):
    def _A_ref(x, k_cache, v_cache, wq, wo):
        B, Sq, D = x.shape
        H, Dh = 32, 128
        q = (lambda x, *d: x.permute(*d))((x @ wq).reshape(B, Sq, H, Dh), 0, 2, 1, 3)
        scores = torch.einsum("bhqd,bhkd->bhqk", q, k_cache) * (Dh ** -0.5)
        p = _softmax(scores, axis=-1)
        o = torch.einsum("bhqk,bhkd->bhqd", p, v_cache)
        return (lambda x, *d: x.permute(*d))(o, 0, 2, 1, 3).reshape(B, Sq, H * Dh) @ wo

    def _B_ref(x, k_cache, v_cache, wq, wo):
        B, Sq, D = x.shape
        Hq, Dh = 32, 128
        Hkv = k_cache.shape[1]
        rep = Hq // Hkv
        q = (lambda x, *d: x.permute(*d))((x @ wq).reshape(B, Sq, Hq, Dh), 0, 2, 1, 3)
        k = (lambda x, n, axis: torch.repeat_interleave(x, n, dim=axis))(k_cache, rep, axis=1)
        v = (lambda x, n, axis: torch.repeat_interleave(x, n, dim=axis))(v_cache, rep, axis=1)
        scores = torch.einsum("bhqd,bhkd->bhqk", q, k) * (Dh ** -0.5)
        p = _softmax(scores, axis=-1)
        o = torch.einsum("bhqk,bhkd->bhqd", p, v)
        return (lambda x, *d: x.permute(*d))(o, 0, 2, 1, 3).reshape(B, Sq, Hq * Dh) @ wo

    a = _A_ref(A_x, A_k_cache, A_v_cache, A_wq, A_wo)
    b = _B_ref(B_x, B_k_cache, B_v_cache, B_wq, B_wo)
    return torch.concatenate([a, b], axis=-1)
```

```asm
; @launch grid=(256,1,1) block=(384,1,1) lds=44032
.amdgcn_target "amdgcn-amd-amdhsa--gfx950"
.text
.globl concat_heads__mha_block_cached__gqa_block_cached__decode_kernel
.p2align 12
.fill 832, 4, 0xbf810000
.p2align 8
.type concat_heads__mha_block_cached__gqa_block_cached__decode_kernel,@function
concat_heads__mha_block_cached__gqa_block_cached__decode_kernel:
    s_cmp_ge_u32 s2, 256
    s_cbranch_scc1 L_end
    s_load_dwordx16 s[4:19], s[0:1], 0
    s_load_dwordx8 s[20:27], s[0:1], 64
    s_load_dwordx2 s[28:29], s[0:1], 96
    v_lshrrev_b32 v1, 6, v0
    v_and_b32 v0, 63, v0
    v_readfirstlane_b32 s3, v1
    s_and_b32 s30, s2, 7
    s_lshr_b32 s31, s2, 3
    s_lshr_b32 s60, s31, 3
    s_lshl2_add_u32 s52, s30, s60
    v_lshrrev_b32 v2, 4, v0
    v_lshlrev_b32 v14, 4, v0
    s_bfe_u32 s53, s31, 0x10002
    s_bitcmp1_b32 36, s3
    s_cbranch_scc0 L_str_pro
    s_and_b32 s66, s31, 7
    s_lshl_b32 s60, s66, 19
    s_lshl_b32 s62, s52, 8
    s_add_u32 s60, s60, s62
    s_lshl_b32 s61, s66, 7
    v_and_b32 v4, 0xf0, v14
    v_bfe_u32 v7, v0, 3, 1
    v_lshlrev_b32 v6, 5, v2
    v_lshl_add_u32 v6, v7, 10, v6
    v_lshl_add_u32 v5, v2, 17, v4
    s_mov_b32 s42, 4194304
    s_mov_b32 s43, 0x20000
    s_movk_i32 s46, 0x800
    s_mov_b32 s47, 0x20000
    s_cmp_eq_u32 s3, 2
    s_waitcnt lgkmcnt(0)
    s_cselect_b32 s40, s10, s20
    s_cselect_b32 s41, s11, s21
    s_cselect_b32 s44, s4, s14
    s_cselect_b32 s45, s5, s15
    s_load_dword s93, s[28:29], 0
    s_cbranch_scc0 L_qb_pro
    buffer_load_dwordx4 v[16:19], v6, s[44:47], s61 offen
    buffer_load_dwordx4 v[20:23], v6, s[44:47], s61 offen offset:16
    buffer_load_dwordx4 v[64:67], v5, s[40:43], s60 offen nt
    s_addk_i32 s60, 0x2000
    buffer_load_dwordx4 v[68:71], v5, s[40:43], s60 offen nt
    s_addk_i32 s60, 0x2000
    buffer_load_dwordx4 v[72:75], v5, s[40:43], s60 offen nt
    s_addk_i32 s60, 0x2000
    buffer_load_dwordx4 v[76:79], v5, s[40:43], s60 offen nt
    s_addk_i32 s60, 0x2000
    buffer_load_dwordx4 v[80:83], v5, s[40:43], s60 offen nt
    s_addk_i32 s60, 0x2000
    buffer_load_dwordx4 v[84:87], v5, s[40:43], s60 offen nt
    s_addk_i32 s60, 0x2000
    buffer_load_dwordx4 v[88:91], v5, s[40:43], s60 offen nt
    s_addk_i32 s60, 0x2000
    buffer_load_dwordx4 v[92:95], v5, s[40:43], s60 offen nt
    s_addk_i32 s60, 0x2000
    buffer_load_dwordx4 v[96:99], v5, s[40:43], s60 offen nt
    s_addk_i32 s60, 0x2000
    buffer_load_dwordx4 v[100:103], v5, s[40:43], s60 offen nt
    s_addk_i32 s60, 0x2000
    buffer_load_dwordx4 v[104:107], v5, s[40:43], s60 offen nt
    s_addk_i32 s60, 0x2000
    buffer_load_dwordx4 v[108:111], v5, s[40:43], s60 offen nt
    s_addk_i32 s60, 0x2000
    buffer_load_dwordx4 v[112:115], v5, s[40:43], s60 offen nt
    s_addk_i32 s60, 0x2000
    buffer_load_dwordx4 v[116:119], v5, s[40:43], s60 offen nt
    s_addk_i32 s60, 0x2000
    buffer_load_dwordx4 v[120:123], v5, s[40:43], s60 offen nt
    s_addk_i32 s60, 0x2000
    buffer_load_dwordx4 v[124:127], v5, s[40:43], s60 offen nt
    s_barrier
    s_branch L_qsetup
L_str_pro:
    s_lshl_b32 s60, s53, 5
    s_add_u32 s60, s60, s52
    s_and_b32 s62, s31, 3
    s_lshl2_add_u32 s65, s60, s62
    v_and_b32 v10, 3, v0
    v_bfe_u32 v9, v0, 2, 2
    v_lshl_add_u32 v10, v2, 2, v10
    v_lshlrev_b32 v10, 4, v10
    v_lshl_add_u32 v42, v9, 8, v10
    s_cmp_ge_u32 s3, 3
    s_cselect_b32 s80, 1, 0
    s_xor_b32 s64, s3, s80
    s_and_b32 s64, s64, 1
    s_bitcmp1_b32 s65, 2
    s_cselect_b32 s60, 48, 0
    s_bitcmp1_b32 s65, 3
    s_cselect_b32 s61, 40, 0
    s_add_u32 s60, s60, s61
    s_bitcmp1_b32 s65, 4
    s_cselect_b32 s61, 32, 0
    s_add_u32 s60, s60, s61
    s_bitcmp1_b32 s65, 5
    s_cselect_b32 s61, 38, 0
    s_add_u32 s60, s60, s61
    s_bitcmp1_b32 s65, 6
    s_cselect_b32 s61, 34, 0
    s_add_u32 s60, s60, s61
    s_bitcmp1_b32 s65, 7
    s_cselect_b32 s61, 18, 0
    s_add_u32 s60, s60, s61
    s_lshl_b32 s76, s64, 12
    s_bfe_u32 s61, s65, 0x10000
    s_lshl_b32 s61, s61, 16
    s_or_b32 s76, s76, s61
    s_bfe_u32 s61, s65, 0x10001
    s_lshl_b32 s61, s61, 21
    s_or_b32 s76, s76, s61
    s_bfe_u32 s61, s60, 0x10001
    s_lshl_b32 s58, s61, 14
    s_bfe_u32 s61, s60, 0x40002
    s_lshl_b32 s61, s61, 17
    s_or_b32 s58, s58, s61
    s_mov_b32 s54, s58
    s_mov_b32 s55, 1982464
    s_mov_b32 s84, s76
    s_xor_b32 s85, s84, 8192
    s_xor_b32 s86, s84, 32768
    s_xor_b32 s87, s85, 32768
    s_sub_u32 s54, s54, s80
    s_and_b32 s54, s54, s55
    s_lshr_b32 s60, s65, 2
    s_lshl_b32 s60, s60, 22
    v_mov_b32 v40, 9472
    v_mov_b32 v4, 0
    v_mov_b32 v5, 0
    ds_write_b64 v40, v[4:5] offset:0
    ds_write_b64 v40, v[4:5] offset:8
    ds_write_b64 v40, v[4:5] offset:16
    ds_write_b64 v40, v[4:5] offset:24
    ds_write_b64 v40, v[4:5] offset:32
    s_waitcnt lgkmcnt(0)
    s_add_u32 s32, s6, s60
    s_addc_u32 s33, s7, 0
    s_mov_b32 s34, 4194304
    s_mov_b32 s35, 0x20000
    s_xor_b32 s88, s54, s84
    s_barrier
    buffer_load_dwordx4 v[64:67], v42, s[32:35], s88 offen offset:0 nt
    buffer_load_dwordx4 v[68:71], v42, s[32:35], s88 offen offset:1024 nt
    buffer_load_dwordx4 v[72:75], v42, s[32:35], s88 offen offset:2048 nt
    buffer_load_dwordx4 v[76:79], v42, s[32:35], s88 offen offset:3072 nt
    s_xor_b32 s88, s54, s85
    s_branch L_stream
L_qb_pro:
    s_mov_b32 s48, s28
    s_mov_b32 s49, s29
    s_mov_b32 s50, 1969280
    s_mov_b32 s51, 0x20000
    v_min_u32 v8, 49, v0
    v_lshlrev_b32 v8, 7, v8
    s_mul_i32 s62, s2, 7680
    s_add_u32 s62, s62, 1408
    s_barrier
    buffer_load_dword v63, v8, s[48:51], s62 offen
    buffer_load_dwordx4 v[16:19], v6, s[44:47], s61 offen
    buffer_load_dwordx4 v[20:23], v6, s[44:47], s61 offen offset:16
    buffer_load_dwordx4 v[64:67], v5, s[40:43], s60 offen nt
    s_addk_i32 s60, 0x2000
    buffer_load_dwordx4 v[68:71], v5, s[40:43], s60 offen nt
    s_addk_i32 s60, 0x2000
    buffer_load_dwordx4 v[72:75], v5, s[40:43], s60 offen nt
    s_addk_i32 s60, 0x2000
    buffer_load_dwordx4 v[76:79], v5, s[40:43], s60 offen nt
    s_addk_i32 s60, 0x2000
    buffer_load_dwordx4 v[80:83], v5, s[40:43], s60 offen nt
    s_addk_i32 s60, 0x2000
    buffer_load_dwordx4 v[84:87], v5, s[40:43], s60 offen nt
    s_addk_i32 s60, 0x2000
    s_waitcnt vmcnt(5)
    buffer_load_dwordx4 v[88:91], v5, s[40:43], s60 offen nt
    s_addk_i32 s60, 0x2000
    s_waitcnt vmcnt(5)
    buffer_load_dwordx4 v[92:95], v5, s[40:43], s60 offen nt
    s_addk_i32 s60, 0x2000
    s_waitcnt vmcnt(5)
    buffer_load_dwordx4 v[96:99], v5, s[40:43], s60 offen nt
    s_addk_i32 s60, 0x2000
    s_waitcnt vmcnt(5)
    buffer_load_dwordx4 v[100:103], v5, s[40:43], s60 offen nt
    s_addk_i32 s60, 0x2000
    s_waitcnt vmcnt(5)
    buffer_load_dwordx4 v[104:107], v5, s[40:43], s60 offen nt
    s_addk_i32 s60, 0x2000
    s_waitcnt vmcnt(5)
    buffer_load_dwordx4 v[108:111], v5, s[40:43], s60 offen nt
    s_addk_i32 s60, 0x2000
    s_waitcnt vmcnt(5)
    buffer_load_dwordx4 v[112:115], v5, s[40:43], s60 offen nt
    s_addk_i32 s60, 0x2000
    s_waitcnt vmcnt(5)
    buffer_load_dwordx4 v[116:119], v5, s[40:43], s60 offen nt
    s_addk_i32 s60, 0x2000
    s_waitcnt vmcnt(5)
    buffer_load_dwordx4 v[120:123], v5, s[40:43], s60 offen nt
    s_addk_i32 s60, 0x2000
    s_waitcnt vmcnt(5)
    buffer_load_dwordx4 v[124:127], v5, s[40:43], s60 offen nt
L_qsetup:
    s_mov_b32 s98, 0
L_svc:
    s_setprio 3
    s_mov_b32 s62, 0xaaaaaaaa
    s_mov_b32 s63, 0xaaaaaaaa
    v_mov_b32 v8, 0x0c0c0100
    v_mov_b32 v9, 0x01000c0c
    v_cndmask_b32 v60, v8, v9, s[62:63]
    v_mov_b32 v8, 0x0c0c0302
    v_mov_b32 v9, 0x03020c0c
    v_cndmask_b32 v61, v8, v9, s[62:63]
    v_mov_b32 v62, 0x0c0c0c0c
    s_mov_b32 s62, 0x03030303
    s_mov_b32 s63, 0x03030303
    v_cndmask_b32 v24, v62, v60, s[62:63]
    v_cndmask_b32 v25, v62, v61, s[62:63]
    s_lshl_b64 s[62:63], s[62:63], 2
    v_cndmask_b32 v26, v62, v60, s[62:63]
    v_cndmask_b32 v27, v62, v61, s[62:63]
    s_lshl_b64 s[62:63], s[62:63], 2
    v_cndmask_b32 v28, v62, v60, s[62:63]
    v_cndmask_b32 v29, v62, v61, s[62:63]
    s_lshl_b64 s[62:63], s[62:63], 2
    v_cndmask_b32 v30, v62, v60, s[62:63]
    v_cndmask_b32 v31, v62, v61, s[62:63]
    v_and_b32 v3, 7, v0
    v_mov_b32 v59, 9472
    v_mov_b32 v60, 0xff
    v_mov_b32 v61, 1.0
    s_mov_b32 s48, s28
    s_mov_b32 s49, s29
    s_mov_b32 s50, 1969280
    s_mov_b32 s51, 0x20000
    s_mul_i32 s68, s2, 7680
    s_add_u32 s68, s68, 128
    s_cmp_eq_u32 s98, 1
    s_cbranch_scc1 L_finisher
    v_mov_b32 v40, 0
    v_mov_b32 v41, 0
    v_mov_b32 v42, 0
    v_mov_b32 v43, 0
    s_cmp_eq_u32 s3, 2
    s_cselect_b32 s76, 1024, 0
    s_add_u32 s76, s76, s68
    s_add_u32 s76, s76, 5504
    v_lshrrev_b32 v8, 5, v0
    v_bfe_u32 v9, v0, 3, 2
    v_lshlrev_b32 v12, 8, v9
    v_lshl_add_u32 v12, v3, 4, v12
    v_lshlrev_b32 v11, 6, v9
    v_lshl_add_u32 v11, v3, 1, v11
    s_mov_b32 s60, 61440
    v_mul_lo_u32 v10, v8, s60
    v_add_u32 v10, v10, v12
    v_mul_lo_u32 v13, v3, s60
    s_and_b32 s60, s2, 0xc7
    s_mul_i32 s75, s60, 7680
    s_lshl_b32 s61, s53, 7
    s_add_u32 s74, s75, s61
    s_add_u32 s74, s74, 6656
    s_add_u32 s75, s75, 7680
    s_add_u32 s85, s74, 122880
    s_add_u32 s86, s74, 245760
    s_add_u32 s87, s74, 368640
    s_getreg_b32 s67, hwreg(HW_REG_XCC_ID, 0, 4)
    s_add_u32 s77, s68, 7552
    s_waitcnt lgkmcnt(0)
    s_add_u32 s94, s93, 0x01010101
    s_not_b32 s95, s94
    s_and_b32 s36, s94, 0xff
    s_bfe_u32 s37, s94, 0x80008
    s_bfe_u32 s38, s94, 0x80010
    s_lshr_b32 s39, s94, 24
    v_mov_b32 v48, s67
    v_mov_b32 v49, s67
    v_mov_b32 v50, s94
    v_mov_b32 v51, s95
    s_waitcnt vmcnt(0)
L_projmm:
    v_perm_b32 v32, v16, v16, v24
    v_perm_b32 v33, v16, v16, v26
    v_perm_b32 v34, v16, v16, v28
    v_perm_b32 v35, v16, v16, v30
    v_perm_b32 v36, v16, v16, v25
    v_perm_b32 v37, v16, v16, v27
    v_perm_b32 v38, v16, v16, v29
    v_perm_b32 v39, v16, v16, v31
    v_mfma_f32_16x16x32_bf16 v[40:43], v[64:67], v[32:35], v[40:43]
    v_perm_b32 v32, v17, v17, v24
    v_perm_b32 v33, v17, v17, v26
    v_perm_b32 v34, v17, v17, v28
    v_perm_b32 v35, v17, v17, v30
    v_mfma_f32_16x16x32_bf16 v[40:43], v[68:71], v[36:39], v[40:43]
    v_perm_b32 v36, v17, v17, v25
    v_perm_b32 v37, v17, v17, v27
    v_perm_b32 v38, v17, v17, v29
    v_perm_b32 v39, v17, v17, v31
    v_mfma_f32_16x16x32_bf16 v[40:43], v[72:75], v[32:35], v[40:43]
    v_perm_b32 v32, v18, v18, v24
    v_perm_b32 v33, v18, v18, v26
    v_perm_b32 v34, v18, v18, v28
    v_perm_b32 v35, v18, v18, v30
    v_mfma_f32_16x16x32_bf16 v[40:43], v[76:79], v[36:39], v[40:43]
    v_perm_b32 v36, v18, v18, v25
    v_perm_b32 v37, v18, v18, v27
    v_perm_b32 v38, v18, v18, v29
    v_perm_b32 v39, v18, v18, v31
    v_mfma_f32_16x16x32_bf16 v[40:43], v[80:83], v[32:35], v[40:43]
    v_perm_b32 v32, v19, v19, v24
    v_perm_b32 v33, v19, v19, v26
    v_perm_b32 v34, v19, v19, v28
    v_perm_b32 v35, v19, v19, v30
    v_mfma_f32_16x16x32_bf16 v[40:43], v[84:87], v[36:39], v[40:43]
    v_perm_b32 v36, v19, v19, v25
    v_perm_b32 v37, v19, v19, v27
    v_perm_b32 v38, v19, v19, v29
    v_perm_b32 v39, v19, v19, v31
    v_mfma_f32_16x16x32_bf16 v[40:43], v[88:91], v[32:35], v[40:43]
    v_perm_b32 v32, v20, v20, v24
    v_perm_b32 v33, v20, v20, v26
    v_perm_b32 v34, v20, v20, v28
    v_perm_b32 v35, v20, v20, v30
    s_waitcnt vmcnt(8)
    v_mfma_f32_16x16x32_bf16 v[40:43], v[92:95], v[36:39], v[40:43]
    v_perm_b32 v36, v20, v20, v25
    v_perm_b32 v37, v20, v20, v27
    v_perm_b32 v38, v20, v20, v29
    v_perm_b32 v39, v20, v20, v31
    s_waitcnt vmcnt(7)
    v_mfma_f32_16x16x32_bf16 v[40:43], v[96:99], v[32:35], v[40:43]
    v_perm_b32 v32, v21, v21, v24
    v_perm_b32 v33, v21, v21, v26
    v_perm_b32 v34, v21, v21, v28
    v_perm_b32 v35, v21, v21, v30
    s_waitcnt vmcnt(6)
    v_mfma_f32_16x16x32_bf16 v[40:43], v[100:103], v[36:39], v[40:43]
    v_perm_b32 v36, v21, v21, v25
    v_perm_b32 v37, v21, v21, v27
    v_perm_b32 v38, v21, v21, v29
    v_perm_b32 v39, v21, v21, v31
    s_waitcnt vmcnt(5)
    v_mfma_f32_16x16x32_bf16 v[40:43], v[104:107], v[32:35], v[40:43]
    v_perm_b32 v32, v22, v22, v24
    v_perm_b32 v33, v22, v22, v26
    v_perm_b32 v34, v22, v22, v28
    v_perm_b32 v35, v22, v22, v30
    s_waitcnt vmcnt(4)
    v_mfma_f32_16x16x32_bf16 v[40:43], v[108:111], v[36:39], v[40:43]
    v_perm_b32 v36, v22, v22, v25
    v_perm_b32 v37, v22, v22, v27
    v_perm_b32 v38, v22, v22, v29
    v_perm_b32 v39, v22, v22, v31
    s_waitcnt vmcnt(3)
    v_mfma_f32_16x16x32_bf16 v[40:43], v[112:115], v[32:35], v[40:43]
    v_perm_b32 v32, v23, v23, v24
    v_perm_b32 v33, v23, v23, v26
    v_perm_b32 v34, v23, v23, v28
    v_perm_b32 v35, v23, v23, v30
    s_waitcnt vmcnt(2)
    v_mfma_f32_16x16x32_bf16 v[40:43], v[116:119], v[36:39], v[40:43]
    v_perm_b32 v36, v23, v23, v25
    v_perm_b32 v37, v23, v23, v27
    v_perm_b32 v38, v23, v23, v29
    v_perm_b32 v39, v23, v23, v31
    s_waitcnt vmcnt(1)
    v_mfma_f32_16x16x32_bf16 v[40:43], v[120:123], v[32:35], v[40:43]
    s_waitcnt vmcnt(0)
    v_mfma_f32_16x16x32_bf16 v[40:43], v[124:127], v[36:39], v[40:43]
    s_mov_b32 s60, 262144
    s_cmp_eq_u32 s98, 1
    s_nop 5
    v_mul_f32 v40, v40, v61
    v_mul_f32 v41, v41, v61
    v_mul_f32 v42, v42, v61
    v_mul_f32 v43, v43, v61
    v_bfi_b32 v40, v60, s36, v40
    v_bfi_b32 v41, v60, s37, v41
    v_bfi_b32 v42, v60, s38, v42
    v_bfi_b32 v43, v60, s39, v43
    s_cbranch_scc0 L_q0
    buffer_store_dwordx4 v[40:43], v14, s[48:51], s76 offen sc1
    s_branch L_ret_fin
L_q0:
    s_cmp_eq_u32 s3, 2
    s_cbranch_scc0 L_ret_qb
    buffer_store_dwordx4 v[40:43], v14, s[48:51], s76 offen
    s_mov_b64 exec, 0xff
    buffer_store_dwordx4 v[48:51], v14, s[48:51], s77 offen
    s_mov_b64 exec, -1
L_qa:
    s_sleep 3
    buffer_load_dwordx4 v[64:67], v10, s[48:51], s74 offen sc1
    buffer_load_dwordx4 v[68:71], v10, s[48:51], s85 offen sc1
    buffer_load_dwordx4 v[72:75], v10, s[48:51], s86 offen sc1
    buffer_load_dwordx4 v[76:79], v10, s[48:51], s87 offen sc1
    s_waitcnt vmcnt(3)
    v_xor_b32 v64, s36, v64
    v_xor_b32 v65, s37, v65
    v_xor_b32 v66, s38, v66
    v_xor_b32 v67, s39, v67
    v_or3_b32 v8, v64, v65, v66
    v_or_b32 v8, v8, v67
    s_waitcnt vmcnt(2)
    v_xor_b32 v68, s36, v68
    v_xor_b32 v69, s37, v69
    v_xor_b32 v70, s38, v70
    v_xor_b32 v71, s39, v71
    v_or3_b32 v8, v8, v68, v69
    v_or3_b32 v8, v8, v70, v71
    v_add_f32 v64, v64, v68
    v_add_f32 v65, v65, v69
    v_add_f32 v66, v66, v70
    v_add_f32 v67, v67, v71
    s_waitcnt vmcnt(1)
    v_xor_b32 v72, s36, v72
    v_xor_b32 v73, s37, v73
    v_xor_b32 v74, s38, v74
    v_xor_b32 v75, s39, v75
    v_or3_b32 v8, v8, v72, v73
    v_or3_b32 v8, v8, v74, v75
    v_add_f32 v64, v64, v72
    v_add_f32 v65, v65, v73
    v_add_f32 v66, v66, v74
    v_add_f32 v67, v67, v75
    s_waitcnt vmcnt(0)
    v_xor_b32 v76, s36, v76
    v_xor_b32 v77, s37, v77
    v_xor_b32 v78, s38, v78
    v_xor_b32 v79, s39, v79
    v_or3_b32 v8, v8, v76, v77
    v_or3_b32 v8, v8, v78, v79
    v_add_f32 v64, v64, v76
    v_add_f32 v65, v65, v77
    v_add_f32 v66, v66, v78
    v_add_f32 v67, v67, v79
    v_and_b32 v8, 0xff, v8
    v_cmp_ne_u32 vcc, 0, v8
    s_cbranch_vccz L_qaok
    s_sub_u32 s60, s60, 1
    s_cbranch_scc1 L_end
    s_cmp_eq_u32 s60, 262138
    s_cbranch_scc0 L_qa
    buffer_store_dwordx4 v[40:43], v14, s[48:51], s76 offen sc1
    s_mov_b64 exec, 0xff
    buffer_store_dwordx4 v[48:51], v14, s[48:51], s77 offen sc1
    s_mov_b64 exec, -1
    s_branch L_qa
L_qaok:
    v_permlane32_swap_b32 v64, v66
    v_permlane32_swap_b32 v65, v67
    v_add_f32 v64, v64, v66
    v_add_f32 v65, v65, v67
    v_and_b32 v8, 32, v0
    v_add_u32 v11, v11, v8
    v_cvt_pk_bf16_f32 v64, v64, v65
    v_mov_b32 v8, 1
    v_mov_b32 v9, s93
    ds_write_b16 v11, v64 offset:8192
    ds_write_b16_d16_hi v11, v64 offset:8208
    ds_write_b32 v59, v9 offset:16
    ds_write_b32 v59, v8 offset:12
    buffer_load_dwordx4 v[44:47], v13, s[48:51], s75 offen sc1
    s_waitcnt vmcnt(0)
    v_xor_b32 v46, s94, v46
    v_xor_b32 v47, s95, v47
    v_xor_b32 v44, s67, v44
    v_or3_b32 v46, v46, v47, v44
    v_cmp_ne_u32 vcc, 0, v46
    s_cbranch_vccz L_end
    buffer_store_dwordx4 v[40:43], v14, s[48:51], s76 offen sc1
    s_mov_b64 exec, 0xff
    buffer_store_dwordx4 v[48:51], v14, s[48:51], s77 offen sc1
    s_mov_b64 exec, -1
    s_endpgm
.p2align 12
L_stream:
    v_mov_b32 v13, v42
    v_lshl_add_u32 v15, v9, 9, v10
    v_add_u32 v38, 8192, v10
    v_lshl_add_u32 v39, v9, 8, v38
    v_add_u32 v39, 256, v39
    s_lshl_b32 s60, s64, 13
    s_add_u32 s60, s60, 10240
    v_lshl_add_u32 v128, v2, 4, s60
    v_lshl_add_u32 v8, v2, 2, v9
    s_add_u32 s60, s60, 16384
    v_lshl_add_u32 v129, v8, 4, s60
    v_mov_b32 v131, 0xff
    v_lshlrev_b32 v132, 3, v0
    s_mov_b32 s62, 0xaaaaaaaa
    s_mov_b32 s63, 0xaaaaaaaa
    v_mov_b32 v8, 0x0c0c0100
    v_mov_b32 v9, 0x01000c0c
    v_cndmask_b32 v60, v8, v9, s[62:63]
    v_mov_b32 v8, 0x0c0c0302
    v_mov_b32 v9, 0x03020c0c
    v_cndmask_b32 v61, v8, v9, s[62:63]
    v_mov_b32 v62, 0x0c0c0c0c
    s_mov_b32 s62, 0x33333333
    s_mov_b32 s63, 0x33333333
    v_cndmask_b32 v34, v62, v60, s[62:63]
    v_cndmask_b32 v35, v62, v61, s[62:63]
    v_cndmask_b32 v36, v60, v62, s[62:63]
    v_cndmask_b32 v37, v61, v62, s[62:63]
    v_mov_b32 v41, 1
    s_mov_b32 s59, 0x3e0293ee
    s_mov_b32 s48, s28
    s_mov_b32 s49, s29
    s_mov_b32 s50, 1969280
    s_mov_b32 s51, 0x20000
    s_mul_i32 s68, s2, 7680
    s_mul_i32 s60, s64, 640
    s_add_u32 s68, s68, s60
    s_mov_b32 s56, 31
    s_mov_b32 s57, 0
    s_mov_b32 s78, 0
    s_lshl_b32 s60, s64, 2
    s_add_u32 s60, s60, 9496
    v_mov_b32 v134, s60
    v_mov_b32 v133, 0
    s_mul_i32 s60, s80, 7936
    v_add_u32 v11, s60, v128
    s_bitcmp1_b32 s65, 2
    s_cselect_b32 s60, 8, 0
    s_bitcmp1_b32 s65, 3
    s_cselect_b32 s61, 8, 0
    s_add_u32 s60, s60, s61
    s_bitcmp1_b32 s65, 4
    s_cselect_b32 s61, 14, 0
    s_add_u32 s60, s60, s61
    s_bitcmp1_b32 s65, 5
    s_cselect_b32 s61, 2, 0
    s_add_u32 s60, s60, s61
    s_bitcmp1_b32 s65, 6
    s_cselect_b32 s61, 2, 0
    s_add_u32 s60, s60, s61
    s_bitcmp1_b32 s65, 7
    s_cselect_b32 s61, 6, 0
    s_add_u32 s60, s60, s61
    s_lshl_b32 s79, s64, 12
    s_bfe_u32 s61, s65, 0x10000
    s_lshl_b32 s61, s61, 15
    s_or_b32 s79, s79, s61
    s_bfe_u32 s61, s65, 0x10001
    s_lshl_b32 s61, s61, 21
    s_or_b32 s79, s79, s61
    s_bfe_u32 s61, s65, 0x20002
    s_lshl_b32 s61, s61, 19
    s_or_b32 s79, s79, s61
    s_bfe_u32 s61, s60, 0x10001
    s_lshl_b32 s77, s61, 14
    s_bfe_u32 s61, s60, 0x20002
    s_lshl_b32 s61, s61, 17
    s_or_b32 s77, s77, s61
    s_mov_b32 s66, 64
    s_mov_b32 s62, 0x00010001
    s_mov_b32 s63, 0x00010001
    v_mov_b32 v10, 0xff61b1e6
    s_waitcnt vmcnt(3)
    buffer_load_dwordx4 v[80:83], v42, s[32:35], s88 offen offset:0 nt
    s_waitcnt vmcnt(3)
    buffer_load_dwordx4 v[84:87], v42, s[32:35], s88 offen offset:1024 nt
    s_waitcnt vmcnt(3)
    buffer_load_dwordx4 v[88:91], v42, s[32:35], s88 offen offset:2048 nt
    s_waitcnt vmcnt(3)
    buffer_load_dwordx4 v[92:95], v42, s[32:35], s88 offen offset:3072 nt
    s_xor_b32 s88, s54, s86
    s_waitcnt vmcnt(3)
    buffer_load_dwordx4 v[96:99], v42, s[32:35], s88 offen offset:0 nt
    s_waitcnt vmcnt(3)
    buffer_load_dwordx4 v[100:103], v42, s[32:35], s88 offen offset:1024 nt
    s_waitcnt vmcnt(3)
    buffer_load_dwordx4 v[104:107], v42, s[32:35], s88 offen offset:2048 nt
    s_waitcnt vmcnt(3)
    buffer_load_dwordx4 v[108:111], v42, s[32:35], s88 offen offset:3072 nt
    s_xor_b32 s88, s54, s87
    s_waitcnt vmcnt(3)
    buffer_load_dwordx4 v[112:115], v42, s[32:35], s88 offen offset:0 nt
    s_waitcnt vmcnt(3)
    buffer_load_dwordx4 v[116:119], v42, s[32:35], s88 offen offset:1024 nt
    s_waitcnt vmcnt(3)
    buffer_load_dwordx4 v[120:123], v42, s[32:35], s88 offen offset:2048 nt
    s_waitcnt vmcnt(3)
    buffer_load_dwordx4 v[124:127], v42, s[32:35], s88 offen offset:3072 nt
    s_orn2_b32 s54, s54, s55
    s_add_u32 s54, s54, 1
    s_and_b32 s54, s54, s55
    s_xor_b32 s88, s54, s84
    s_mov_b32 s60, 1048576
L_waitqa:
    ds_read_b32 v4, v40 offset:12
    ds_read_b32 v5, v40 offset:16
    ds_read_b128 v[44:47], v38
    s_waitcnt lgkmcnt(0)
    v_readfirstlane_b32 s61, v4
    v_readfirstlane_b32 s93, v5
    s_sub_u32 s60, s60, 1
    s_cbranch_scc1 L_end
    s_cmp_eq_u32 s61, 0
    s_cbranch_scc1 L_waitqa
    s_add_u32 s94, s93, 0x01010101
    s_not_b32 s95, s94
    s_and_b32 s36, s94, 0xff
    s_bfe_u32 s37, s94, 0x80008
    s_bfe_u32 s38, s94, 0x80010
    s_lshr_b32 s39, s94, 24
    s_cmp_eq_u32 s80, 0
    s_cbranch_scc1 L_loopK
    s_mov_b32 s34, 0
    s_mov_b32 s56, 1
    s_mov_b32 s57, 4
    s_mov_b32 s69, 0
    s_mov_b32 s78, 1
    s_mov_b64 vcc, -1
    v_mov_b32 v134, 9512
    s_branch L_bodyK
L_loopK:
    s_waitcnt lgkmcnt(0)
    v_readfirstlane_b32 s69, v133
    ds_read_b32 v133, v134 offset:8
    s_cmp_le_u32 s56, s78
    s_cselect_b64 vcc, -1, 0
    s_bitcmp1_b32 s69, 4
    s_cselect_b64 vcc, -1, vcc
    s_cmp_eq_u32 s56, 1
    s_cbranch_scc1 L_switchK
L_bodyK:
    s_mov_b64 exec, 1
    ds_add_u32 v134, v41
    s_mov_b64 exec, -1
    s_bitcmp1_b32 s69, 0
    s_cbranch_vccnz L_thf1
    s_cbranch_scc1 L_thd1
    s_waitcnt vmcnt(9)
L_thd1:
    s_waitcnt vmcnt(10)
L_thf1:
    s_waitcnt vmcnt(15)
    v_mfma_f32_16x16x32_bf16 v[48:51], v[64:67], v[44:47], 0
    buffer_load_dwordx4 v[64:67], v42, s[32:35], s88 offen offset:0 nt
    s_cbranch_vccnz L_thf2
    s_cbranch_scc1 L_thd2
    s_waitcnt vmcnt(9)
L_thd2:
    s_waitcnt vmcnt(10)
L_thf2:
    s_waitcnt vmcnt(15)
    v_mfma_f32_16x16x32_bf16 v[52:55], v[68:71], v[44:47], 0
    buffer_load_dwordx4 v[68:71], v42, s[32:35], s88 offen offset:1024 nt
    s_cbranch_vccnz L_thf3
    s_cbranch_scc1 L_thd3
    s_waitcnt vmcnt(9)
L_thd3:
    s_waitcnt vmcnt(10)
L_thf3:
    s_waitcnt vmcnt(15)
    v_mfma_f32_16x16x32_bf16 v[56:59], v[72:75], v[44:47], 0
    buffer_load_dwordx4 v[72:75], v42, s[32:35], s88 offen offset:2048 nt
    s_cbranch_vccnz L_thf4
    s_cbranch_scc1 L_thd4
    s_waitcnt vmcnt(9)
L_thd4:
    s_waitcnt vmcnt(10)
L_thf4:
    s_waitcnt vmcnt(15)
    v_mfma_f32_16x16x32_bf16 v[60:63], v[76:79], v[44:47], 0
    buffer_load_dwordx4 v[76:79], v42, s[32:35], s88 offen offset:3072 nt
    s_xor_b32 s88, s54, s85
    s_nop 2
    v_mov_b32_dpp v4, v48 quad_perm:[0,0,0,0] row_mask:0xf bank_mask:0xf
    v_mov_b32_dpp v5, v52 quad_perm:[0,0,0,0] row_mask:0xf bank_mask:0xf
    v_mov_b32_dpp v6, v56 quad_perm:[0,0,0,0] row_mask:0xf bank_mask:0xf
    v_mov_b32_dpp v7, v60 quad_perm:[0,0,0,0] row_mask:0xf bank_mask:0xf
    v_add_f32_dpp v4, v49, v4 quad_perm:[1,1,1,1] row_mask:0xf bank_mask:0xf
    v_add_f32_dpp v5, v53, v5 quad_perm:[1,1,1,1] row_mask:0xf bank_mask:0xf
    v_add_f32_dpp v6, v57, v6 quad_perm:[1,1,1,1] row_mask:0xf bank_mask:0xf
    v_add_f32_dpp v7, v61, v7 quad_perm:[1,1,1,1] row_mask:0xf bank_mask:0xf
    v_add_f32_dpp v4, v50, v4 quad_perm:[2,2,2,2] row_mask:0xf bank_mask:0xf
    v_add_f32_dpp v5, v54, v5 quad_perm:[2,2,2,2] row_mask:0xf bank_mask:0xf
    v_add_f32_dpp v6, v58, v6 quad_perm:[2,2,2,2] row_mask:0xf bank_mask:0xf
    v_add_f32_dpp v7, v62, v7 quad_perm:[2,2,2,2] row_mask:0xf bank_mask:0xf
    v_add_f32_dpp v4, v51, v4 quad_perm:[3,3,3,3] row_mask:0xf bank_mask:0xf
    v_add_f32_dpp v5, v55, v5 quad_perm:[3,3,3,3] row_mask:0xf bank_mask:0xf
    v_add_f32_dpp v6, v59, v6 quad_perm:[3,3,3,3] row_mask:0xf bank_mask:0xf
    v_add_f32_dpp v7, v63, v7 quad_perm:[3,3,3,3] row_mask:0xf bank_mask:0xf
    v_max3_f32 v10, v10, v4, v5
    v_max3_f32 v10, v10, v6, v7
    s_mov_b64 exec, s[62:63]
    ds_write_b128 v11, v[4:7]
    s_mov_b64 exec, -1
    v_add_u32 v11, s66, v11
    s_mov_b64 exec, 1
    ds_add_u32 v134, v41
    s_mov_b64 exec, -1
    s_bitcmp1_b32 s69, 1
    s_cbranch_vccnz L_thf5
    s_cbranch_scc1 L_thd5
    s_waitcnt vmcnt(9)
L_thd5:
    s_waitcnt vmcnt(10)
L_thf5:
    s_waitcnt vmcnt(15)
    v_mfma_f32_16x16x32_bf16 v[48:51], v[80:83], v[44:47], 0
    buffer_load_dwordx4 v[80:83], v42, s[32:35], s88 offen offset:0 nt
    s_cbranch_vccnz L_thf6
    s_cbranch_scc1 L_thd6
    s_waitcnt vmcnt(9)
L_thd6:
    s_waitcnt vmcnt(10)
L_thf6:
    s_waitcnt vmcnt(15)
    v_mfma_f32_16x16x32_bf16 v[52:55], v[84:87], v[44:47], 0
    buffer_load_dwordx4 v[84:87], v42, s[32:35], s88 offen offset:1024 nt
    s_cbranch_vccnz L_thf7
    s_cbranch_scc1 L_thd7
    s_waitcnt vmcnt(9)
L_thd7:
    s_waitcnt vmcnt(10)
L_thf7:
    s_waitcnt vmcnt(15)
    v_mfma_f32_16x16x32_bf16 v[56:59], v[88:91], v[44:47], 0
    buffer_load_dwordx4 v[88:91], v42, s[32:35], s88 offen offset:2048 nt
    s_cbranch_vccnz L_thf8
    s_cbranch_scc1 L_thd8
    s_waitcnt vmcnt(9)
L_thd8:
    s_waitcnt vmcnt(10)
L_thf8:
    s_waitcnt vmcnt(15)
    v_mfma_f32_16x16x32_bf16 v[60:63], v[92:95], v[44:47], 0
    buffer_load_dwordx4 v[92:95], v42, s[32:35], s88 offen offset:3072 nt
    s_xor_b32 s88, s54, s86
    s_nop 2
    v_mov_b32_dpp v16, v48 quad_perm:[0,0,0,0] row_mask:0xf bank_mask:0xf
    v_mov_b32_dpp v17, v52 quad_perm:[0,0,0,0] row_mask:0xf bank_mask:0xf
    v_mov_b32_dpp v18, v56 quad_perm:[0,0,0,0] row_mask:0xf bank_mask:0xf
    v_mov_b32_dpp v19, v60 quad_perm:[0,0,0,0] row_mask:0xf bank_mask:0xf
    v_add_f32_dpp v16, v49, v16 quad_perm:[1,1,1,1] row_mask:0xf bank_mask:0xf
    v_add_f32_dpp v17, v53, v17 quad_perm:[1,1,1,1] row_mask:0xf bank_mask:0xf
    v_add_f32_dpp v18, v57, v18 quad_perm:[1,1,1,1] row_mask:0xf bank_mask:0xf
    v_add_f32_dpp v19, v61, v19 quad_perm:[1,1,1,1] row_mask:0xf bank_mask:0xf
    v_add_f32_dpp v16, v50, v16 quad_perm:[2,2,2,2] row_mask:0xf bank_mask:0xf
    v_add_f32_dpp v17, v54, v17 quad_perm:[2,2,2,2] row_mask:0xf bank_mask:0xf
    v_add_f32_dpp v18, v58, v18 quad_perm:[2,2,2,2] row_mask:0xf bank_mask:0xf
    v_add_f32_dpp v19, v62, v19 quad_perm:[2,2,2,2] row_mask:0xf bank_mask:0xf
    v_add_f32_dpp v16, v51, v16 quad_perm:[3,3,3,3] row_mask:0xf bank_mask:0xf
    v_add_f32_dpp v17, v55, v17 quad_perm:[3,3,3,3] row_mask:0xf bank_mask:0xf
    v_add_f32_dpp v18, v59, v18 quad_perm:[3,3,3,3] row_mask:0xf bank_mask:0xf
    v_add_f32_dpp v19, v63, v19 quad_perm:[3,3,3,3] row_mask:0xf bank_mask:0xf
    v_max3_f32 v10, v10, v16, v17
    v_max3_f32 v10, v10, v18, v19
    s_mov_b64 exec, s[62:63]
    ds_write_b128 v11, v[16:19]
    s_mov_b64 exec, -1
    v_add_u32 v11, s66, v11
    s_mov_b64 exec, 1
    ds_add_u32 v134, v41
    s_mov_b64 exec, -1
    s_bitcmp1_b32 s69, 2
    s_cbranch_vccnz L_thf9
    s_cbranch_scc1 L_thd9
    s_waitcnt vmcnt(9)
L_thd9:
    s_waitcnt vmcnt(10)
L_thf9:
    s_waitcnt vmcnt(15)
    v_mfma_f32_16x16x32_bf16 v[48:51], v[96:99], v[44:47], 0
    buffer_load_dwordx4 v[96:99], v42, s[32:35], s88 offen offset:0 nt
    s_cbranch_vccnz L_thf10
    s_cbranch_scc1 L_thd10
    s_waitcnt vmcnt(9)
L_thd10:
    s_waitcnt vmcnt(10)
L_thf10:
    s_waitcnt vmcnt(15)
    v_mfma_f32_16x16x32_bf16 v[52:55], v[100:103], v[44:47], 0
    buffer_load_dwordx4 v[100:103], v42, s[32:35], s88 offen offset:1024 nt
    s_cbranch_vccnz L_thf11
    s_cbranch_scc1 L_thd11
    s_waitcnt vmcnt(9)
L_thd11:
    s_waitcnt vmcnt(10)
L_thf11:
    s_waitcnt vmcnt(15)
    v_mfma_f32_16x16x32_bf16 v[56:59], v[104:107], v[44:47], 0
    buffer_load_dwordx4 v[104:107], v42, s[32:35], s88 offen offset:2048 nt
    s_cbranch_vccnz L_thf12
    s_cbranch_scc1 L_thd12
    s_waitcnt vmcnt(9)
L_thd12:
    s_waitcnt vmcnt(10)
L_thf12:
    s_waitcnt vmcnt(15)
    v_mfma_f32_16x16x32_bf16 v[60:63], v[108:111], v[44:47], 0
    buffer_load_dwordx4 v[108:111], v42, s[32:35], s88 offen offset:3072 nt
    s_xor_b32 s88, s54, s87
    s_nop 2
    v_mov_b32_dpp v4, v48 quad_perm:[0,0,0,0] row_mask:0xf bank_mask:0xf
    v_mov_b32_dpp v5, v52 quad_perm:[0,0,0,0] row_mask:0xf bank_mask:0xf
    v_mov_b32_dpp v6, v56 quad_perm:[0,0,0,0] row_mask:0xf bank_mask:0xf
    v_mov_b32_dpp v7, v60 quad_perm:[0,0,0,0] row_mask:0xf bank_mask:0xf
    v_add_f32_dpp v4, v49, v4 quad_perm:[1,1,1,1] row_mask:0xf bank_mask:0xf
    v_add_f32_dpp v5, v53, v5 quad_perm:[1,1,1,1] row_mask:0xf bank_mask:0xf
    v_add_f32_dpp v6, v57, v6 quad_perm:[1,1,1,1] row_mask:0xf bank_mask:0xf
    v_add_f32_dpp v7, v61, v7 quad_perm:[1,1,1,1] row_mask:0xf bank_mask:0xf
    v_add_f32_dpp v4, v50, v4 quad_perm:[2,2,2,2] row_mask:0xf bank_mask:0xf
    v_add_f32_dpp v5, v54, v5 quad_perm:[2,2,2,2] row_mask:0xf bank_mask:0xf
    v_add_f32_dpp v6, v58, v6 quad_perm:[2,2,2,2] row_mask:0xf bank_mask:0xf
    v_add_f32_dpp v7, v62, v7 quad_perm:[2,2,2,2] row_mask:0xf bank_mask:0xf
    v_add_f32_dpp v4, v51, v4 quad_perm:[3,3,3,3] row_mask:0xf bank_mask:0xf
    v_add_f32_dpp v5, v55, v5 quad_perm:[3,3,3,3] row_mask:0xf bank_mask:0xf
    v_add_f32_dpp v6, v59, v6 quad_perm:[3,3,3,3] row_mask:0xf bank_mask:0xf
    v_add_f32_dpp v7, v63, v7 quad_perm:[3,3,3,3] row_mask:0xf bank_mask:0xf
    v_max3_f32 v10, v10, v4, v5
    v_max3_f32 v10, v10, v6, v7
    s_mov_b64 exec, s[62:63]
    ds_write_b128 v11, v[4:7]
    s_mov_b64 exec, -1
    v_add_u32 v11, s66, v11
    s_mov_b64 exec, 1
    ds_add_u32 v134, v41
    s_mov_b64 exec, -1
    s_bitcmp1_b32 s69, 3
    s_cbranch_vccnz L_thf13
    s_cbranch_scc1 L_thd13
    s_waitcnt vmcnt(9)
L_thd13:
    s_waitcnt vmcnt(10)
L_thf13:
    s_waitcnt vmcnt(15)
    v_mfma_f32_16x16x32_bf16 v[48:51], v[112:115], v[44:47], 0
    buffer_load_dwordx4 v[112:115], v42, s[32:35], s88 offen offset:0 nt
    s_cbranch_vccnz L_thf14
    s_cbranch_scc1 L_thd14
    s_waitcnt vmcnt(9)
L_thd14:
    s_waitcnt vmcnt(10)
L_thf14:
    s_waitcnt vmcnt(15)
    v_mfma_f32_16x16x32_bf16 v[52:55], v[116:119], v[44:47], 0
    buffer_load_dwordx4 v[116:119], v42, s[32:35], s88 offen offset:1024 nt
    s_cbranch_vccnz L_thf15
    s_cbranch_scc1 L_thd15
    s_waitcnt vmcnt(9)
L_thd15:
    s_waitcnt vmcnt(10)
L_thf15:
    s_waitcnt vmcnt(15)
    v_mfma_f32_16x16x32_bf16 v[56:59], v[120:123], v[44:47], 0
    buffer_load_dwordx4 v[120:123], v42, s[32:35], s88 offen offset:2048 nt
    s_cbranch_vccnz L_thf16
    s_cbranch_scc1 L_thd16
    s_waitcnt vmcnt(9)
L_thd16:
    s_waitcnt vmcnt(10)
L_thf16:
    s_waitcnt vmcnt(15)
    v_mfma_f32_16x16x32_bf16 v[60:63], v[124:127], v[44:47], 0
    buffer_load_dwordx4 v[124:127], v42, s[32:35], s88 offen offset:3072 nt
    s_orn2_b32 s54, s54, s55
    s_add_u32 s54, s54, 1
    s_and_b32 s54, s54, s55
    s_xor_b32 s88, s54, s84
    v_mov_b32_dpp v16, v48 quad_perm:[0,0,0,0] row_mask:0xf bank_mask:0xf
    v_mov_b32_dpp v17, v52 quad_perm:[0,0,0,0] row_mask:0xf bank_mask:0xf
    v_mov_b32_dpp v18, v56 quad_perm:[0,0,0,0] row_mask:0xf bank_mask:0xf
    v_mov_b32_dpp v19, v60 quad_perm:[0,0,0,0] row_mask:0xf bank_mask:0xf
    v_add_f32_dpp v16, v49, v16 quad_perm:[1,1,1,1] row_mask:0xf bank_mask:0xf
    v_add_f32_dpp v17, v53, v17 quad_perm:[1,1,1,1] row_mask:0xf bank_mask:0xf
    v_add_f32_dpp v18, v57, v18 quad_perm:[1,1,1,1] row_mask:0xf bank_mask:0xf
    v_add_f32_dpp v19, v61, v19 quad_perm:[1,1,1,1] row_mask:0xf bank_mask:0xf
    v_add_f32_dpp v16, v50, v16 quad_perm:[2,2,2,2] row_mask:0xf bank_mask:0xf
    v_add_f32_dpp v17, v54, v17 quad_perm:[2,2,2,2] row_mask:0xf bank_mask:0xf
    v_add_f32_dpp v18, v58, v18 quad_perm:[2,2,2,2] row_mask:0xf bank_mask:0xf
    v_add_f32_dpp v19, v62, v19 quad_perm:[2,2,2,2] row_mask:0xf bank_mask:0xf
    v_add_f32_dpp v16, v51, v16 quad_perm:[3,3,3,3] row_mask:0xf bank_mask:0xf
    v_add_f32_dpp v17, v55, v17 quad_perm:[3,3,3,3] row_mask:0xf bank_mask:0xf
    v_add_f32_dpp v18, v59, v18 quad_perm:[3,3,3,3] row_mask:0xf bank_mask:0xf
    v_add_f32_dpp v19, v63, v19 quad_perm:[3,3,3,3] row_mask:0xf bank_mask:0xf
    v_max3_f32 v10, v10, v16, v17
    v_max3_f32 v10, v10, v18, v19
    s_mov_b64 exec, s[62:63]
    ds_write_b128 v11, v[16:19]
    s_mov_b64 exec, -1
    v_add_u32 v11, s66, v11
    s_sub_u32 s56, s56, 1
    s_cmp_lg_u32 s56, 0
    s_cbranch_scc1 L_loopK
    s_mov_b32 s56, 8
    s_cmp_eq_u32 s57, 1
    s_cbranch_scc0 L_endKA
    v_mov_b32 v9, v10
    s_nop 1
    v_permlane32_swap_b32 v10, v9
    v_max_f32 v10, v10, v9
    v_mov_b32 v9, v10
    s_nop 1
    v_permlane16_swap_b32 v10, v9
    v_max_f32 v10, v10, v9
    s_mov_b32 s57, 2
    v_add_u32 v38, s66, v129
L_startV:
    v_mul_f32 v11, s59, v10
    v_sub_f32 v11, 0, v11
    v_fma_f32 v4, v144, s59, v11
    v_fma_f32 v5, v145, s59, v11
    v_fma_f32 v6, v146, s59, v11
    v_fma_f32 v7, v147, s59, v11
    ds_read_b128 v[48:51], v38
    v_add_u32 v38, s66, v38
    v_exp_f32 v4, v4
    v_exp_f32 v5, v5
    v_exp_f32 v6, v6
    v_exp_f32 v7, v7
    v_mov_b32 v12, 0
    v_cvt_pk_bf16_f32 v24, v4, v5
    v_cvt_pk_bf16_f32 v25, v6, v7
    v_add_f32 v8, v4, v5
    v_add_f32 v9, v6, v7
    v_perm_b32 v26, v24, v24, v34
    v_perm_b32 v27, v24, v24, v36
    v_perm_b32 v28, v24, v24, v35
    v_perm_b32 v29, v24, v24, v37
    v_perm_b32 v30, v25, v25, v34
    v_perm_b32 v31, v25, v25, v36
    v_perm_b32 v32, v25, v25, v35
    v_perm_b32 v33, v25, v25, v37
    v_add_f32 v8, v8, v9
    s_waitcnt lgkmcnt(1)
    v_mov_b32 v16, 0
    v_mov_b32 v17, 0
    v_mov_b32 v18, 0
    v_mov_b32 v19, 0
    v_mov_b32 v20, 0
    v_mov_b32 v21, 0
    v_mov_b32 v22, 0
    v_mov_b32 v23, 0
L_loopV:
    s_waitcnt lgkmcnt(0)
    v_readfirstlane_b32 s69, v133
    ds_read_b32 v133, v134 offset:8
    s_cmp_le_u32 s56, s78
    s_cselect_b64 vcc, -1, 0
    s_bitcmp1_b32 s69, 4
    s_cselect_b64 vcc, -1, vcc
    s_cmp_eq_u32 s56, 1
    s_cbranch_scc1 L_switchV
L_bodyV:
    s_bitcmp1_b32 s69, 0
    v_add_f32 v12, v12, v8
    s_cbranch_vccnz L_thf17
    s_cbranch_scc1 L_thd17
    s_waitcnt vmcnt(9)
L_thd17:
    s_waitcnt vmcnt(10)
L_thf17:
    s_waitcnt vmcnt(15)
    v_mfma_f32_16x16x16_bf16 v[16:19], v[64:65], v[26:27], v[16:19]
    v_mfma_f32_16x16x16_bf16 v[20:23], v[66:67], v[26:27], v[20:23]
    buffer_load_dwordx4 v[64:67], v42, s[32:35], s88 offen offset:0 nt
    v_fma_f32 v4, v48, s59, v11
    v_fma_f32 v5, v49, s59, v11
    v_fma_f32 v6, v50, s59, v11
    v_fma_f32 v7, v51, s59, v11
    ds_read_b128 v[48:51], v38
    v_add_u32 v38, s66, v38
    s_mov_b64 exec, 1
    ds_add_u32 v134, v41
    s_mov_b64 exec, -1
    s_cbranch_vccnz L_thf18
    s_cbranch_scc1 L_thd18
    s_waitcnt vmcnt(9)
L_thd18:
    s_waitcnt vmcnt(10)
L_thf18:
    s_waitcnt vmcnt(15)
    v_mfma_f32_16x16x16_bf16 v[16:19], v[68:69], v[28:29], v[16:19]
    v_mfma_f32_16x16x16_bf16 v[20:23], v[70:71], v[28:29], v[20:23]
    buffer_load_dwordx4 v[68:71], v42, s[32:35], s88 offen offset:1024 nt
    v_exp_f32 v4, v4
    v_exp_f32 v5, v5
    v_exp_f32 v6, v6
    v_exp_f32 v7, v7
    s_cbranch_vccnz L_thf19
    s_cbranch_scc1 L_thd19
    s_waitcnt vmcnt(9)
L_thd19:
    s_waitcnt vmcnt(10)
L_thf19:
    s_waitcnt vmcnt(15)
    v_mfma_f32_16x16x16_bf16 v[16:19], v[72:73], v[30:31], v[16:19]
    v_mfma_f32_16x16x16_bf16 v[20:23], v[74:75], v[30:31], v[20:23]
    buffer_load_dwordx4 v[72:75], v42, s[32:35], s88 offen offset:2048 nt
    v_cvt_pk_bf16_f32 v24, v4, v5
    v_cvt_pk_bf16_f32 v25, v6, v7
    v_add_f32 v8, v4, v5
    v_add_f32 v9, v6, v7
    v_perm_b32 v136, v24, v24, v34
    v_perm_b32 v137, v24, v24, v36
    v_perm_b32 v138, v24, v24, v35
    v_perm_b32 v139, v24, v24, v37
    s_cbranch_vccnz L_thf20
    s_cbranch_scc1 L_thd20
    s_waitcnt vmcnt(9)
L_thd20:
    s_waitcnt vmcnt(10)
L_thf20:
    s_waitcnt vmcnt(15)
    v_mfma_f32_16x16x16_bf16 v[16:19], v[76:77], v[32:33], v[16:19]
    v_mfma_f32_16x16x16_bf16 v[20:23], v[78:79], v[32:33], v[20:23]
    buffer_load_dwordx4 v[76:79], v42, s[32:35], s88 offen offset:3072 nt
    v_perm_b32 v140, v25, v25, v34
    v_perm_b32 v141, v25, v25, v36
    v_perm_b32 v142, v25, v25, v35
    v_perm_b32 v143, v25, v25, v37
    v_add_f32 v8, v8, v9
    s_xor_b32 s88, s54, s85
    s_bitcmp1_b32 s69, 1
    v_add_f32 v12, v12, v8
    s_cbranch_vccnz L_thf21
    s_cbranch_scc1 L_thd21
    s_waitcnt vmcnt(9)
L_thd21:
    s_waitcnt vmcnt(10)
L_thf21:
    s_waitcnt vmcnt(15)
    v_mfma_f32_16x16x16_bf16 v[16:19], v[80:81], v[136:137], v[16:19]
    v_mfma_f32_16x16x16_bf16 v[20:23], v[82:83], v[136:137], v[20:23]
    buffer_load_dwordx4 v[80:83], v42, s[32:35], s88 offen offset:0 nt
    s_waitcnt lgkmcnt(0)
    v_fma_f32 v4, v48, s59, v11
    v_fma_f32 v5, v49, s59, v11
    v_fma_f32 v6, v50, s59, v11
    v_fma_f32 v7, v51, s59, v11
    ds_read_b128 v[48:51], v38
    v_add_u32 v38, s66, v38
    s_mov_b64 exec, 1
    ds_add_u32 v134, v41
    s_mov_b64 exec, -1
    s_cbranch_vccnz L_thf22
    s_cbranch_scc1 L_thd22
    s_waitcnt vmcnt(9)
L_thd22:
    s_waitcnt vmcnt(10)
L_thf22:
    s_waitcnt vmcnt(15)
    v_mfma_f32_16x16x16_bf16 v[16:19], v[84:85], v[138:139], v[16:19]
    v_mfma_f32_16x16x16_bf16 v[20:23], v[86:87], v[138:139], v[20:23]
    buffer_load_dwordx4 v[84:87], v42, s[32:35], s88 offen offset:1024 nt
    v_exp_f32 v4, v4
    v_exp_f32 v5, v5
    v_exp_f32 v6, v6
    v_exp_f32 v7, v7
    s_cbranch_vccnz L_thf23
    s_cbranch_scc1 L_thd23
    s_waitcnt vmcnt(9)
L_thd23:
    s_waitcnt vmcnt(10)
L_thf23:
    s_waitcnt vmcnt(15)
    v_mfma_f32_16x16x16_bf16 v[16:19], v[88:89], v[140:141], v[16:19]
    v_mfma_f32_16x16x16_bf16 v[20:23], v[90:91], v[140:141], v[20:23]
    buffer_load_dwordx4 v[88:91], v42, s[32:35], s88 offen offset:2048 nt
    v_cvt_pk_bf16_f32 v24, v4, v5
    v_cvt_pk_bf16_f32 v25, v6, v7
    v_add_f32 v8, v4, v5
    v_add_f32 v9, v6, v7
    v_perm_b32 v26, v24, v24, v34
    v_perm_b32 v27, v24, v24, v36
    v_perm_b32 v28, v24, v24, v35
    v_perm_b32 v29, v24, v24, v37
    s_cbranch_vccnz L_thf24
    s_cbranch_scc1 L_thd24
    s_waitcnt vmcnt(9)
L_thd24:
    s_waitcnt vmcnt(10)
L_thf24:
    s_waitcnt vmcnt(15)
    v_mfma_f32_16x16x16_bf16 v[16:19], v[92:93], v[142:143], v[16:19]
    v_mfma_f32_16x16x16_bf16 v[20:23], v[94:95], v[142:143], v[20:23]
    buffer_load_dwordx4 v[92:95], v42, s[32:35], s88 offen offset:3072 nt
    v_perm_b32 v30, v25, v25, v34
    v_perm_b32 v31, v25, v25, v36
    v_perm_b32 v32, v25, v25, v35
    v_perm_b32 v33, v25, v25, v37
    v_add_f32 v8, v8, v9
    s_xor_b32 s88, s54, s86
    s_bitcmp1_b32 s69, 2
    v_add_f32 v12, v12, v8
    s_cbranch_vccnz L_thf25
    s_cbranch_scc1 L_thd25
    s_waitcnt vmcnt(9)
L_thd25:
    s_waitcnt vmcnt(10)
L_thf25:
    s_waitcnt vmcnt(15)
    v_mfma_f32_16x16x16_bf16 v[16:19], v[96:97], v[26:27], v[16:19]
    v_mfma_f32_16x16x16_bf16 v[20:23], v[98:99], v[26:27], v[20:23]
    buffer_load_dwordx4 v[96:99], v42, s[32:35], s88 offen offset:0 nt
    s_waitcnt lgkmcnt(0)
    v_fma_f32 v4, v48, s59, v11
    v_fma_f32 v5, v49, s59, v11
    v_fma_f32 v6, v50, s59, v11
    v_fma_f32 v7, v51, s59, v11
    ds_read_b128 v[48:51], v38
    v_add_u32 v38, s66, v38
    s_mov_b64 exec, 1
    ds_add_u32 v134, v41
    s_mov_b64 exec, -1
    s_cbranch_vccnz L_thf26
    s_cbranch_scc1 L_thd26
    s_waitcnt vmcnt(9)
L_thd26:
    s_waitcnt vmcnt(10)
L_thf26:
    s_waitcnt vmcnt(15)
    v_mfma_f32_16x16x16_bf16 v[16:19], v[100:101], v[28:29], v[16:19]
    v_mfma_f32_16x16x16_bf16 v[20:23], v[102:103], v[28:29], v[20:23]
    buffer_load_dwordx4 v[100:103], v42, s[32:35], s88 offen offset:1024 nt
    v_exp_f32 v4, v4
    v_exp_f32 v5, v5
    v_exp_f32 v6, v6
    v_exp_f32 v7, v7
    s_cbranch_vccnz L_thf27
    s_cbranch_scc1 L_thd27
    s_waitcnt vmcnt(9)
L_thd27:
    s_waitcnt vmcnt(10)
L_thf27:
    s_waitcnt vmcnt(15)
    v_mfma_f32_16x16x16_bf16 v[16:19], v[104:105], v[30:31], v[16:19]
    v_mfma_f32_16x16x16_bf16 v[20:23], v[106:107], v[30:31], v[20:23]
    buffer_load_dwordx4 v[104:107], v42, s[32:35], s88 offen offset:2048 nt
    v_cvt_pk_bf16_f32 v24, v4, v5
    v_cvt_pk_bf16_f32 v25, v6, v7
    v_add_f32 v8, v4, v5
    v_add_f32 v9, v6, v7
    v_perm_b32 v136, v24, v24, v34
    v_perm_b32 v137, v24, v24, v36
    v_perm_b32 v138, v24, v24, v35
    v_perm_b32 v139, v24, v24, v37
    s_cbranch_vccnz L_thf28
    s_cbranch_scc1 L_thd28
    s_waitcnt vmcnt(9)
L_thd28:
    s_waitcnt vmcnt(10)
L_thf28:
    s_waitcnt vmcnt(15)
    v_mfma_f32_16x16x16_bf16 v[16:19], v[108:109], v[32:33], v[16:19]
    v_mfma_f32_16x16x16_bf16 v[20:23], v[110:111], v[32:33], v[20:23]
    buffer_load_dwordx4 v[108:111], v42, s[32:35], s88 offen offset:3072 nt
    v_perm_b32 v140, v25, v25, v34
    v_perm_b32 v141, v25, v25, v36
    v_perm_b32 v142, v25, v25, v35
    v_perm_b32 v143, v25, v25, v37
    v_add_f32 v8, v8, v9
    s_xor_b32 s88, s54, s87
    s_bitcmp1_b32 s69, 3
    v_add_f32 v12, v12, v8
    s_cbranch_vccnz L_thf29
    s_cbranch_scc1 L_thd29
    s_waitcnt vmcnt(9)
L_thd29:
    s_waitcnt vmcnt(10)
L_thf29:
    s_waitcnt vmcnt(15)
    v_mfma_f32_16x16x16_bf16 v[16:19], v[112:113], v[136:137], v[16:19]
    v_mfma_f32_16x16x16_bf16 v[20:23], v[114:115], v[136:137], v[20:23]
    buffer_load_dwordx4 v[112:115], v42, s[32:35], s88 offen offset:0 nt
    s_waitcnt lgkmcnt(0)
    v_fma_f32 v4, v48, s59, v11
    v_fma_f32 v5, v49, s59, v11
    v_fma_f32 v6, v50, s59, v11
    v_fma_f32 v7, v51, s59, v11
    ds_read_b128 v[48:51], v38
    v_add_u32 v38, s66, v38
    s_mov_b64 exec, 1
    ds_add_u32 v134, v41
    s_mov_b64 exec, -1
    s_cbranch_vccnz L_thf30
    s_cbranch_scc1 L_thd30
    s_waitcnt vmcnt(9)
L_thd30:
    s_waitcnt vmcnt(10)
L_thf30:
    s_waitcnt vmcnt(15)
    v_mfma_f32_16x16x16_bf16 v[16:19], v[116:117], v[138:139], v[16:19]
    v_mfma_f32_16x16x16_bf16 v[20:23], v[118:119], v[138:139], v[20:23]
    buffer_load_dwordx4 v[116:119], v42, s[32:35], s88 offen offset:1024 nt
    v_exp_f32 v4, v4
    v_exp_f32 v5, v5
    v_exp_f32 v6, v6
    v_exp_f32 v7, v7
    s_cbranch_vccnz L_thf31
    s_cbranch_scc1 L_thd31
    s_waitcnt vmcnt(9)
L_thd31:
    s_waitcnt vmcnt(10)
L_thf31:
    s_waitcnt vmcnt(15)
    v_mfma_f32_16x16x16_bf16 v[16:19], v[120:121], v[140:141], v[16:19]
    v_mfma_f32_16x16x16_bf16 v[20:23], v[122:123], v[140:141], v[20:23]
    buffer_load_dwordx4 v[120:123], v42, s[32:35], s88 offen offset:2048 nt
    v_cvt_pk_bf16_f32 v24, v4, v5
    v_cvt_pk_bf16_f32 v25, v6, v7
    v_add_f32 v8, v4, v5
    v_add_f32 v9, v6, v7
    v_perm_b32 v26, v24, v24, v34
    v_perm_b32 v27, v24, v24, v36
    v_perm_b32 v28, v24, v24, v35
    v_perm_b32 v29, v24, v24, v37
    s_cbranch_vccnz L_thf32
    s_cbranch_scc1 L_thd32
    s_waitcnt vmcnt(9)
L_thd32:
    s_waitcnt vmcnt(10)
L_thf32:
    s_waitcnt vmcnt(15)
    v_mfma_f32_16x16x16_bf16 v[16:19], v[124:125], v[142:143], v[16:19]
    v_mfma_f32_16x16x16_bf16 v[20:23], v[126:127], v[142:143], v[20:23]
    buffer_load_dwordx4 v[124:127], v42, s[32:35], s88 offen offset:3072 nt
    v_perm_b32 v30, v25, v25, v34
    v_perm_b32 v31, v25, v25, v36
    v_perm_b32 v32, v25, v25, v35
    v_perm_b32 v33, v25, v25, v37
    v_add_f32 v8, v8, v9
    s_orn2_b32 s54, s54, s55
    s_add_u32 s54, s54, 1
    s_and_b32 s54, s54, s55
    s_xor_b32 s88, s54, s84
    s_sub_u32 s56, s56, 1
    s_cmp_lg_u32 s56, 0
    s_cbranch_scc1 L_loopV
    v_mov_b32 v9, v12
    v_mul_f32 v4, s59, v10
    s_cmp_eq_u32 s57, 2
    s_cbranch_scc1 L_endVB
    v_permlane32_swap_b32 v12, v9
    v_add_f32 v12, v12, v9
    v_mov_b32 v9, v12
    v_bfi_b32 v24, v131, s36, v16
    v_bfi_b32 v25, v131, s37, v17
    v_bfi_b32 v26, v131, s38, v18
    v_bfi_b32 v27, v131, s39, v19
    v_bfi_b32 v28, v131, s36, v20
    v_bfi_b32 v29, v131, s37, v21
    v_bfi_b32 v30, v131, s38, v22
    v_bfi_b32 v31, v131, s39, v23
    v_permlane16_swap_b32 v12, v9
    v_add_f32 v5, v12, v9
    v_mov_b32 v6, s94
    v_mov_b32 v7, s95
    s_cmp_eq_u32 s67, 2
    s_cbranch_scc0 L_pubslow
    s_mov_b32 exec_lo, 0x000f000f
    s_mov_b32 exec_hi, 0x000f000f
    buffer_store_dwordx4 v[24:27], v15, s[48:51], s68 offen offset:256
    buffer_store_dwordx4 v[28:31], v15, s[48:51], s68 offen offset:512
    s_mov_b64 exec, 0x5555
    buffer_store_dwordx4 v[4:7], v132, s[48:51], s68 offen offset:128
    s_mov_b64 exec, 1
    ds_add_u32 v134, v41
    s_endpgm
L_pubslow:
    s_mov_b32 exec_lo, 0x000f000f
    s_mov_b32 exec_hi, 0x000f000f
    buffer_store_dwordx4 v[24:27], v15, s[48:51], s68 offen offset:256 sc1
    buffer_store_dwordx4 v[28:31], v15, s[48:51], s68 offen offset:512 sc1
    s_mov_b64 exec, 0x5555
    buffer_store_dwordx4 v[4:7], v132, s[48:51], s68 offen offset:128 sc1
    s_mov_b64 exec, 1
    ds_add_u32 v134, v41
    s_endpgm
L_endVB:
    v_mov_b32 v148, v4
    v_mov_b32 v149, v12
    s_mul_i32 s60, s64, 2560
    v_add_u32 v8, s60, v14
    v_add_u32 v9, s60, v132
    ds_write_b128 v8, v[16:19]
    ds_write_b128 v8, v[20:23] offset:1024
    ds_write_b64 v9, v[148:149] offset:2048
    s_mov_b64 exec, 1
    ds_add_u32 v40, v41 offset:8
    s_mov_b64 exec, -1
    s_mov_b32 s56, 32
    s_mov_b32 s57, 3
    s_mov_b32 s66, 64
    s_mov_b32 s78, 1
    v_add_u32 v38, 64, v128
    v_mov_b32 v10, v130
    s_branch L_startV
L_endKA:
    s_cmp_eq_u32 s57, 4
    s_cbranch_scc1 L_endhelp
    s_mov_b32 s60, 1048576
    s_branch L_chkqb
L_waitqb:
    ds_read_b64 v[148:149], v40
    ds_read_b32 v150, v134 offset:24
    ds_read_b128 v[144:147], v39
    s_sub_u32 s60, s60, 1
    s_cbranch_scc1 L_end
L_chkqb:
    s_waitcnt lgkmcnt(0)
    v_readfirstlane_b32 s67, v148
    v_readfirstlane_b32 s61, v149
    v_mov_b32 v44, v144
    v_mov_b32 v45, v145
    v_mov_b32 v46, v146
    v_mov_b32 v47, v147
    s_cmp_eq_u32 s67, 0
    s_cbranch_scc1 L_waitqb
    s_cmp_lt_u32 s61, 2
    s_cbranch_scc1 L_waitqb
    v_max_f32 v130, v10, v150
    s_mov_b32 s57, 1
    v_mov_b32 v11, v129
    s_movk_i32 s66, 0x100
    s_mov_b32 s62, 0x11111111
    s_mov_b32 s63, 0x11111111
    v_mov_b32 v10, 0xff61b1e6
    s_branch L_loopK
L_switchK:
    s_cmp_eq_u32 s57, 0
    s_cbranch_scc0 L_sw1
    ds_read_b64 v[148:149], v40
    ds_read_b32 v150, v134 offset:24
    ds_read_b128 v[144:147], v39
    s_lshr_b32 s60, s65, 4
    s_lshl_b32 s60, s60, 22
    s_add_u32 s32, s16, s60
    s_addc_u32 s33, s17, 0
    s_mov_b32 s34, 4194304
    s_mov_b32 s35, 0x20000
    s_mov_b32 s54, s77
    s_mov_b32 s55, 409600
    s_mov_b32 s84, s79
    s_xor_b32 s85, s84, 8192
    s_xor_b32 s86, s84, 65536
    s_xor_b32 s87, s85, 65536
    s_xor_b32 s88, s54, s84
    v_mov_b32 v42, v13
    s_branch L_bodyK
L_sw1:
    ds_read_b128 v[144:147], v129
    s_lshr_b32 s60, s65, 4
    s_lshl_b32 s60, s60, 22
    s_add_u32 s32, s18, s60
    s_addc_u32 s33, s19, 0
    s_mov_b32 s34, 4194304
    s_mov_b32 s35, 0x20000
    s_mov_b32 s54, s77
    s_mov_b32 s55, 409600
    s_mov_b32 s84, s79
    s_xor_b32 s85, s84, 8192
    s_xor_b32 s86, s84, 65536
    s_xor_b32 s87, s85, 65536
    s_xor_b32 s88, s54, s84
    v_mov_b32 v42, v14
    v_mov_b32 v9, v130
    s_nop 1
    v_permlane32_swap_b32 v130, v9
    v_max_f32 v130, v130, v9
    v_mov_b32 v9, v130
    s_nop 1
    v_permlane16_swap_b32 v130, v9
    v_max_f32 v130, v130, v9
    s_waitcnt lgkmcnt(0)
    s_branch L_bodyK
L_switchV:
    s_mov_b32 s34, 0
    s_cmp_eq_u32 s57, 2
    s_cbranch_scc0 L_bodyV
    ds_read_b128 v[144:147], v128
    s_lshr_b32 s60, s65, 2
    s_lshl_b32 s60, s60, 22
    s_add_u32 s32, s8, s60
    s_addc_u32 s33, s9, 0
    s_mov_b32 s34, 4194304
    s_mov_b32 s35, 0x20000
    s_mov_b32 s54, s58
    s_mov_b32 s55, 1982464
    s_mov_b32 s84, s76
    s_xor_b32 s85, s84, 8192
    s_xor_b32 s86, s84, 32768
    s_xor_b32 s87, s85, 32768
    s_xor_b32 s88, s54, s84
    v_mov_b32 v42, v14
    s_branch L_bodyV
L_endhelp:
    v_mov_b32 v9, v10
    s_nop 1
    v_permlane32_swap_b32 v10, v9
    v_max_f32 v10, v10, v9
    v_mov_b32 v9, v10
    s_nop 1
    v_permlane16_swap_b32 v10, v9
    v_max_f32 v10, v10, v9
    s_lshl_b32 s60, s64, 2
    v_add_u32 v8, s60, v40
    s_mov_b64 exec, 1
    ds_write_b32 v8, v10 offset:48
    ds_add_u32 v40, v41 offset:4
    s_mov_b64 exec, -1
    s_mov_b32 s98, 1
    s_branch L_svc
L_ret_qb:
    buffer_store_dwordx4 v[40:43], v14, s[48:51], s76 offen
    v_and_b32 v8, 31, v0
    s_mov_b32 s60, 61440
    v_mul_lo_u32 v13, v8, s60
    s_mul_i32 s75, s30, 7680
    s_add_u32 s75, s75, 7680
    v_lshrrev_b32 v15, 5, v0
    v_lshl_add_u32 v11, v15, 8, v11
    s_mov_b32 s60, 491520
    v_mul_lo_u32 v10, v15, s60
    v_add_u32 v10, v10, v12
    s_mov_b32 s60, 1048576
L_waitq:
    s_sleep 4
    ds_read_b64 v[8:9], v59 offset:24
    s_waitcnt lgkmcnt(0)
    v_add_u32 v8, v8, v9
    s_sub_u32 s60, s60, 1
    v_readfirstlane_b32 s61, v8
    s_cbranch_scc1 L_end
    s_cmp_lt_u32 s61, 130
    s_cbranch_scc1 L_waitq
    s_mov_b32 s62, 262144
    s_branch L_qg1
L_qg:
    s_cmp_eq_u32 s62, 262141
    s_cbranch_scc0 L_qg2
    buffer_store_dwordx4 v[40:43], v14, s[48:51], s76 offen sc1
    s_mov_b64 exec, 0xff
    buffer_store_dwordx4 v[48:51], v14, s[48:51], s77 offen sc1
    s_mov_b64 exec, -1
L_qg2:
    s_sleep 32
L_qg1:
    s_mul_i32 s60, s30, 7680
    s_lshl_b32 s61, s53, 7
    s_add_u32 s60, s60, s61
    s_add_u32 s60, s60, 5632
    buffer_load_dwordx4 v[64:67], v10, s[48:51], s60 offen sc1
    s_add_u32 s60, s60, 61440
    buffer_load_dwordx4 v[68:71], v10, s[48:51], s60 offen sc1
    s_add_u32 s60, s60, 61440
    buffer_load_dwordx4 v[72:75], v10, s[48:51], s60 offen sc1
    s_add_u32 s60, s60, 61440
    buffer_load_dwordx4 v[76:79], v10, s[48:51], s60 offen sc1
    s_add_u32 s60, s60, 61440
    buffer_load_dwordx4 v[80:83], v10, s[48:51], s60 offen sc1
    s_add_u32 s60, s60, 61440
    buffer_load_dwordx4 v[84:87], v10, s[48:51], s60 offen sc1
    s_add_u32 s60, s60, 61440
    buffer_load_dwordx4 v[88:91], v10, s[48:51], s60 offen sc1
    s_add_u32 s60, s60, 61440
    buffer_load_dwordx4 v[92:95], v10, s[48:51], s60 offen sc1
    s_add_u32 s60, s60, 552960
    buffer_load_dwordx4 v[96:99], v10, s[48:51], s60 offen sc1
    s_add_u32 s60, s60, 61440
    buffer_load_dwordx4 v[100:103], v10, s[48:51], s60 offen sc1
    s_add_u32 s60, s60, 61440
    buffer_load_dwordx4 v[104:107], v10, s[48:51], s60 offen sc1
    s_add_u32 s60, s60, 61440
    buffer_load_dwordx4 v[108:111], v10, s[48:51], s60 offen sc1
    s_add_u32 s60, s60, 61440
    buffer_load_dwordx4 v[112:115], v10, s[48:51], s60 offen sc1
    s_add_u32 s60, s60, 61440
    buffer_load_dwordx4 v[116:119], v10, s[48:51], s60 offen sc1
    s_add_u32 s60, s60, 61440
    buffer_load_dwordx4 v[120:123], v10, s[48:51], s60 offen sc1
    s_add_u32 s60, s60, 61440
    buffer_load_dwordx4 v[124:127], v10, s[48:51], s60 offen sc1
    buffer_load_dwordx4 v[44:47], v13, s[48:51], s75 offen sc1
    s_sub_u32 s62, s62, 1
    s_cbranch_scc1 L_end
    s_waitcnt vmcnt(0)
    v_xor_b32 v64, s36, v64
    v_xor_b32 v65, s37, v65
    v_xor_b32 v66, s38, v66
    v_xor_b32 v67, s39, v67
    v_xor_b32 v68, s36, v68
    v_xor_b32 v69, s37, v69
    v_xor_b32 v70, s38, v70
    v_xor_b32 v71, s39, v71
    v_xor_b32 v72, s36, v72
    v_xor_b32 v73, s37, v73
    v_xor_b32 v74, s38, v74
    v_xor_b32 v75, s39, v75
    v_xor_b32 v76, s36, v76
    v_xor_b32 v77, s37, v77
    v_xor_b32 v78, s38, v78
    v_xor_b32 v79, s39, v79
    v_xor_b32 v80, s36, v80
    v_xor_b32 v81, s37, v81
    v_xor_b32 v82, s38, v82
    v_xor_b32 v83, s39, v83
    v_xor_b32 v84, s36, v84
    v_xor_b32 v85, s37, v85
    v_xor_b32 v86, s38, v86
    v_xor_b32 v87, s39, v87
    v_xor_b32 v88, s36, v88
    v_xor_b32 v89, s37, v89
    v_xor_b32 v90, s38, v90
    v_xor_b32 v91, s39, v91
    v_xor_b32 v92, s36, v92
    v_xor_b32 v93, s37, v93
    v_xor_b32 v94, s38, v94
    v_xor_b32 v95, s39, v95
    v_xor_b32 v96, s36, v96
    v_xor_b32 v97, s37, v97
    v_xor_b32 v98, s38, v98
    v_xor_b32 v99, s39, v99
    v_xor_b32 v100, s36, v100
    v_xor_b32 v101, s37, v101
    v_xor_b32 v102, s38, v102
    v_xor_b32 v103, s39, v103
    v_xor_b32 v104, s36, v104
    v_xor_b32 v105, s37, v105
    v_xor_b32 v106, s38, v106
    v_xor_b32 v107, s39, v107
    v_xor_b32 v108, s36, v108
    v_xor_b32 v109, s37, v109
    v_xor_b32 v110, s38, v110
    v_xor_b32 v111, s39, v111
    v_xor_b32 v112, s36, v112
    v_xor_b32 v113, s37, v113
    v_xor_b32 v114, s38, v114
    v_xor_b32 v115, s39, v115
    v_xor_b32 v116, s36, v116
    v_xor_b32 v117, s37, v117
    v_xor_b32 v118, s38, v118
    v_xor_b32 v119, s39, v119
    v_xor_b32 v120, s36, v120
    v_xor_b32 v121, s37, v121
    v_xor_b32 v122, s38, v122
    v_xor_b32 v123, s39, v123
    v_xor_b32 v124, s36, v124
    v_xor_b32 v125, s37, v125
    v_xor_b32 v126, s38, v126
    v_xor_b32 v127, s39, v127
    v_or3_b32 v8, v64, v65, v66
    v_or3_b32 v8, v8, v67, v68
    v_or3_b32 v8, v8, v69, v70
    v_or3_b32 v8, v8, v71, v72
    v_or3_b32 v8, v8, v73, v74
    v_or3_b32 v8, v8, v75, v76
    v_or3_b32 v8, v8, v77, v78
    v_or3_b32 v8, v8, v79, v80
    v_or3_b32 v8, v8, v81, v82
    v_or3_b32 v8, v8, v83, v84
    v_or3_b32 v8, v8, v85, v86
    v_or3_b32 v8, v8, v87, v88
    v_or3_b32 v8, v8, v89, v90
    v_or3_b32 v8, v8, v91, v92
    v_or3_b32 v8, v8, v93, v94
    v_or3_b32 v8, v8, v95, v96
    v_or3_b32 v8, v8, v97, v98
    v_or3_b32 v8, v8, v99, v100
    v_or3_b32 v8, v8, v101, v102
    v_or3_b32 v8, v8, v103, v104
    v_or3_b32 v8, v8, v105, v106
    v_or3_b32 v8, v8, v107, v108
    v_or3_b32 v8, v8, v109, v110
    v_or3_b32 v8, v8, v111, v112
    v_or3_b32 v8, v8, v113, v114
    v_or3_b32 v8, v8, v115, v116
    v_or3_b32 v8, v8, v117, v118
    v_or3_b32 v8, v8, v119, v120
    v_or3_b32 v8, v8, v121, v122
    v_or3_b32 v8, v8, v123, v124
    v_or3_b32 v8, v8, v125, v126
    v_or_b32 v8, v8, v127
    v_xor_b32 v46, s94, v46
    v_xor_b32 v47, s95, v47
    v_or_b32 v46, v46, v47
    v_and_or_b32 v8, v8, v60, v46
    v_cmp_ne_u32 vcc, 0, v8
    s_cbranch_vccnz L_qg
    v_cmp_ne_u32 vcc, s67, v44
    s_mov_b32 s67, 2
    s_cbranch_vccz L_qgdone
    s_mov_b32 s67, 1
    buffer_store_dwordx4 v[40:43], v14, s[48:51], s76 offen sc1
    s_mov_b64 exec, 0xff
    buffer_store_dwordx4 v[48:51], v14, s[48:51], s77 offen sc1
    s_mov_b64 exec, -1
L_qgdone:
    v_add_f32 v64, v64, v68
    v_add_f32 v65, v65, v69
    v_add_f32 v66, v66, v70
    v_add_f32 v67, v67, v71
    v_add_f32 v64, v64, v72
    v_add_f32 v65, v65, v73
    v_add_f32 v66, v66, v74
    v_add_f32 v67, v67, v75
    v_add_f32 v64, v64, v76
    v_add_f32 v65, v65, v77
    v_add_f32 v66, v66, v78
    v_add_f32 v67, v67, v79
    v_add_f32 v64, v64, v80
    v_add_f32 v65, v65, v81
    v_add_f32 v66, v66, v82
    v_add_f32 v67, v67, v83
    v_add_f32 v64, v64, v84
    v_add_f32 v65, v65, v85
    v_add_f32 v66, v66, v86
    v_add_f32 v67, v67, v87
    v_add_f32 v64, v64, v88
    v_add_f32 v65, v65, v89
    v_add_f32 v66, v66, v90
    v_add_f32 v67, v67, v91
    v_add_f32 v64, v64, v92
    v_add_f32 v65, v65, v93
    v_add_f32 v66, v66, v94
    v_add_f32 v67, v67, v95
    v_cvt_pk_bf16_f32 v64, v64, v64
    v_cvt_pk_bf16_f32 v65, v65, v65
    v_cvt_pk_bf16_f32 v66, v66, v66
    v_cvt_pk_bf16_f32 v67, v67, v67
    ds_write_b16 v11, v64 offset:8448
    ds_write_b16 v11, v65 offset:8464
    ds_write_b16 v11, v66 offset:8480
    ds_write_b16 v11, v67 offset:8496
    v_add_f32 v96, v96, v100
    v_add_f32 v97, v97, v101
    v_add_f32 v98, v98, v102
    v_add_f32 v99, v99, v103
    v_add_f32 v96, v96, v104
    v_add_f32 v97, v97, v105
    v_add_f32 v98, v98, v106
    v_add_f32 v99, v99, v107
    v_add_f32 v96, v96, v108
    v_add_f32 v97, v97, v109
    v_add_f32 v98, v98, v110
    v_add_f32 v99, v99, v111
    v_add_f32 v96, v96, v112
    v_add_f32 v97, v97, v113
    v_add_f32 v98, v98, v114
    v_add_f32 v99, v99, v115
    v_add_f32 v96, v96, v116
    v_add_f32 v97, v97, v117
    v_add_f32 v98, v98, v118
    v_add_f32 v99, v99, v119
    v_add_f32 v96, v96, v120
    v_add_f32 v97, v97, v121
    v_add_f32 v98, v98, v122
    v_add_f32 v99, v99, v123
    v_add_f32 v96, v96, v124
    v_add_f32 v97, v97, v125
    v_add_f32 v98, v98, v126
    v_add_f32 v99, v99, v127
    v_cvt_pk_bf16_f32 v96, v96, v96
    v_cvt_pk_bf16_f32 v97, v97, v97
    v_cvt_pk_bf16_f32 v98, v98, v98
    v_cvt_pk_bf16_f32 v99, v99, v99
    ds_write_b16 v11, v96 offset:8960
    ds_write_b16 v11, v97 offset:8976
    ds_write_b16 v11, v98 offset:8992
    ds_write_b16 v11, v99 offset:9008
    v_mov_b32 v8, s67
    ds_write_b32 v59, v8
    s_endpgm
L_finisher:
    v_and_b32 v4, 0xf0, v14
    v_bfe_u32 v7, v0, 3, 1
    v_lshl_add_u32 v5, v2, 10, v4
    s_lshl_b32 s69, s52, 17
    s_lshl_b32 s62, s53, 12
    s_add_u32 s69, s69, s62
    s_and_b32 s62, s31, 3
    s_lshl_b32 s62, s62, 8
    s_add_u32 s69, s69, s62
    s_cmp_eq_u32 s64, 0
    s_cselect_b32 s40, s12, s22
    s_cselect_b32 s41, s13, s23
    s_mov_b32 s42, 4194304
    s_mov_b32 s43, 0x20000
    s_lshl_b32 s76, s64, 10
    s_mov_b32 s77, s76
    s_add_u32 s76, s76, 3456
    s_cmp_eq_u32 s64, 0
    s_cbranch_scc0 L_parB
    s_and_b32 s60, s2, 0xc7
    s_mul_i32 s74, s60, 7680
    s_add_u32 s74, s74, 128
    s_add_u32 s75, s74, 128
    s_mov_b32 s78, 640
    s_branch L_par
L_parB:
    s_mul_i32 s74, s30, 7680
    s_add_u32 s74, s74, 1408
    s_lshr_b32 s60, s31, 3
    s_lshl_b32 s61, s60, 9
    s_add_u32 s75, s74, s61
    s_add_u32 s75, s75, 128
    s_lshl_b32 s61, s60, 5
    s_add_u32 s74, s74, s61
    s_mov_b32 s78, 491520
L_par:
    s_lshl_b32 s60, s53, 8
    s_add_u32 s84, s75, s60
    s_add_u32 s85, s84, s78
    s_add_u32 s86, s84, 245760
    s_add_u32 s87, s86, s78
    s_add_u32 s88, s84, 983040
    s_add_u32 s89, s85, 983040
    s_add_u32 s90, s86, 983040
    s_add_u32 s91, s87, 983040
    s_add_u32 s92, s74, 983040
    s_mov_b32 s60, 61440
    v_mul_lo_u32 v15, v2, s60
    v_add_u32 v15, v15, v4
    v_and_b32 v8, 3, v0
    v_xor_b32 v8, v8, v2
    v_lshl_add_u32 v8, v7, 2, v8
    v_mul_lo_u32 v13, v8, s60
    v_bfe_u32 v8, v0, 2, 1
    v_mul_lo_u32 v8, v8, s78
    v_add_u32 v13, v13, v8
    v_lshrrev_b32 v8, 3, v0
    v_and_b32 v9, 7, v8
    v_lshrrev_b32 v8, 3, v8
    v_lshl_add_u32 v8, v8, 5, v9
    s_mov_b32 s60, 7680
    v_mul_lo_u32 v12, v8, s60
    v_and_b32 v10, 7, v0
    v_lshl_add_u32 v12, v10, 4, v12
    s_lshl_b32 s60, s64, 8
    s_add_u32 s60, s60, 9536
    v_lshrrev_b32 v8, 1, v2
    v_lshlrev_b32 v8, 7, v8
    v_and_b32 v9, 1, v2
    v_lshl_add_u32 v8, v9, 2, v8
    v_and_b32 v9, 3, v0
    v_lshl_add_u32 v8, v9, 5, v8
    v_bfe_u32 v9, v0, 2, 2
    v_lshlrev_b32 v9, 3, v9
    v_add3_u32 v57, v8, v9, s60
    v_lshlrev_b32 v8, 7, v7
    v_lshl_add_u32 v8, v2, 5, v8
    v_add_u32 v58, s60, v8
    s_lshr_b32 s81, s2, 5
    s_mul_i32 s60, s64, 4
    s_xor_b32 s81, s81, s60
    s_and_b32 s61, s2, 3
    s_mul_i32 s80, s61, 61440
    s_add_u32 s80, s80, s76
    s_add_u32 s80, s80, 128
    s_and_b32 s63, s2, 31
    s_lshr_b32 s63, s63, 2
    s_lshl_b32 s63, s63, 3
    s_lshl_b32 s60, s63, 4
    s_add_u32 s80, s80, s60
    s_lshl_b32 s61, s61, 8
    s_add_u32 s77, s77, s61
    s_lshr_b32 s61, s63, 4
    s_lshl_b32 s61, s61, 6
    s_add_u32 s77, s77, s61
    s_bfe_u32 s61, s63, 0x10003
    s_lshl_b32 s61, s61, 11
    s_add_u32 s77, s77, s61
    s_and_b32 s61, s63, 7
    s_lshl_b32 s61, s61, 1
    s_add_u32 s77, s77, s61
    v_and_b32 v8, 1, v2
    v_lshrrev_b32 v9, 1, v2
    v_lshl_add_u32 v8, v8, 1, v9
    v_lshlrev_b32 v11, 4, v8
    v_lshl_add_u32 v11, v10, 1, v11
    s_add_u32 s76, s76, s68
    v_mov_b32 v160, 0xff61b1e6
    v_mov_b32 v40, 0
    v_mov_b32 v41, 0
    v_mov_b32 v42, 0
    v_mov_b32 v43, 0
    s_mov_b32 s44, s24
    s_mov_b32 s45, s25
    s_mov_b32 s46, 4096
    s_mov_b32 s47, 0x20000
    s_cmp_eq_u32 s64, 0
    s_cbranch_scc1 L_waitA
    s_mov_b32 s60, 1048576
L_waitB:
    s_sleep 4
    ds_read_b32 v8, v59 offset:8
    s_waitcnt lgkmcnt(0)
    v_readfirstlane_b32 s61, v8
    s_sub_u32 s60, s60, 1
    s_cbranch_scc1 L_end
    s_cmp_lt_u32 s61, 2
    s_cbranch_scc1 L_waitB
    v_lshlrev_b32 v10, 3, v0
    ds_read_b32 v53, v59
    ds_read_b128 v[128:131], v14
    ds_read_b128 v[132:135], v14 offset:1024
    ds_read_b64 v[44:45], v10 offset:2048
    ds_read_b128 v[136:139], v14 offset:2560
    ds_read_b128 v[140:143], v14 offset:3584
    ds_read_b64 v[46:47], v10 offset:4608
    s_waitcnt lgkmcnt(0)
    v_readfirstlane_b32 s67, v53
    v_max_f32 v48, v44, v46
    v_sub_f32 v8, v44, v48
    v_sub_f32 v9, v46, v48
    v_exp_f32 v8, v8
    v_exp_f32 v9, v9
    s_nop 0
    v_mul_f32 v49, v45, v8
    v_fmac_f32 v49, v47, v9
    v_mov_b32 v50, v49
    s_nop 1
    v_permlane32_swap_b32 v49, v50
    v_add_f32 v49, v49, v50
    v_mov_b32 v50, v49
    s_nop 1
    v_permlane16_swap_b32 v49, v50
    v_add_f32 v49, v49, v50
    v_mov_b32 v50, s94
    v_mov_b32 v51, s95
    v_mul_f32 v128, v128, v8
    v_fmac_f32 v128, v136, v9
    v_mul_f32 v129, v129, v8
    v_fmac_f32 v129, v137, v9
    v_mul_f32 v130, v130, v8
    v_fmac_f32 v130, v138, v9
    v_mul_f32 v131, v131, v8
    v_fmac_f32 v131, v139, v9
    v_mul_f32 v132, v132, v8
    v_fmac_f32 v132, v140, v9
    v_mul_f32 v133, v133, v8
    v_fmac_f32 v133, v141, v9
    v_mul_f32 v134, v134, v8
    v_fmac_f32 v134, v142, v9
    v_mul_f32 v135, v135, v8
    v_fmac_f32 v135, v143, v9
    v_bfi_b32 v128, v60, s36, v128
    v_bfi_b32 v129, v60, s37, v129
    v_bfi_b32 v130, v60, s38, v130
    v_bfi_b32 v131, v60, s39, v131
    v_bfi_b32 v132, v60, s36, v132
    v_bfi_b32 v133, v60, s37, v133
    v_bfi_b32 v134, v60, s38, v134
    v_bfi_b32 v135, v60, s39, v135
    v_and_b32 v8, 3, v0
    v_lshl_add_u32 v8, v2, 2, v8
    v_lshlrev_b32 v8, 4, v8
    v_bfe_u32 v9, v0, 2, 2
    v_lshl_add_u32 v52, v9, 9, v8
    s_add_u32 s60, s68, 1280
    s_cmp_eq_u32 s67, 2
    s_cbranch_scc1 L_pubBfast
    buffer_store_dwordx4 v[128:131], v52, s[48:51], s60 offen offset:128 sc1
    buffer_store_dwordx4 v[132:135], v52, s[48:51], s60 offen offset:384 sc1
    s_mov_b64 exec, 0x5555
    buffer_store_dwordx4 v[48:51], v10, s[48:51], s60 offen sc1
    s_mov_b64 exec, -1
    s_branch L_pubBdone
L_pubBfast:
    buffer_store_dwordx4 v[128:131], v52, s[48:51], s60 offen offset:128
    buffer_store_dwordx4 v[132:135], v52, s[48:51], s60 offen offset:384
    s_mov_b64 exec, 0x5555
    buffer_store_dwordx4 v[48:51], v10, s[48:51], s60 offen
    s_mov_b64 exec, -1
L_pubBdone:
    s_waitcnt vmcnt(0)
    s_mov_b32 s60, 1048576
L_waitg:
    s_sleep 4
    ds_read_b64 v[8:9], v59 offset:24
    s_waitcnt lgkmcnt(0)
    v_add_u32 v8, v8, v9
    s_sub_u32 s60, s60, 1
    v_readfirstlane_b32 s61, v8
    s_cbranch_scc1 L_end
    s_cmp_lt_u32 s61, 402
    s_cbranch_scc1 L_waitg
    s_mov_b32 s60, 262144
L_g1:
    buffer_load_dwordx4 v[160:163], v13, s[48:51], s92 offen sc1
    buffer_load_dwordx4 v[144:147], v15, s[48:51], s88 offen sc1
    buffer_load_dwordx4 v[148:151], v15, s[48:51], s89 offen sc1
    buffer_load_dwordx4 v[152:155], v15, s[48:51], s90 offen sc1
    buffer_load_dwordx4 v[156:159], v15, s[48:51], s91 offen sc1
    s_sub_u32 s60, s60, 1
    s_cbranch_scc1 L_end
    s_waitcnt vmcnt(4)
    v_xor_b32 v9, s94, v162
    v_xor_b32 v10, s95, v163
    v_or_b32 v9, v9, v10
    s_waitcnt vmcnt(3)
    v_xor_b32 v144, s36, v144
    v_xor_b32 v145, s37, v145
    v_xor_b32 v146, s38, v146
    v_xor_b32 v147, s39, v147
    v_or3_b32 v8, v144, v145, v146
    v_or_b32 v8, v8, v147
    s_waitcnt vmcnt(2)
    v_xor_b32 v148, s36, v148
    v_xor_b32 v149, s37, v149
    v_xor_b32 v150, s38, v150
    v_xor_b32 v151, s39, v151
    v_or3_b32 v8, v8, v148, v149
    v_or3_b32 v8, v8, v150, v151
    s_waitcnt vmcnt(1)
    v_xor_b32 v152, s36, v152
    v_xor_b32 v153, s37, v153
    v_xor_b32 v154, s38, v154
    v_xor_b32 v155, s39, v155
    v_or3_b32 v8, v8, v152, v153
    v_or3_b32 v8, v8, v154, v155
    s_waitcnt vmcnt(0)
    v_xor_b32 v156, s36, v156
    v_xor_b32 v157, s37, v157
    v_xor_b32 v158, s38, v158
    v_xor_b32 v159, s39, v159
    v_or3_b32 v8, v8, v156, v157
    v_or3_b32 v8, v8, v158, v159
    v_and_or_b32 v8, v8, v60, v9
    v_cmp_ne_u32 vcc, 0, v8
    s_cbranch_vccnz L_g1
    s_branch L_fin
L_waitA:
    s_lshl_b32 s61, s30, 7
    s_add_u32 s96, s61, 1966208
    s_lshl_b32 s61, s31, 2
    v_mov_b32 v44, s61
    v_and_b32 v45, 31, v0
    v_lshlrev_b32 v45, 2, v45
    s_and_b32 s97, s94, 0xffff0000
    v_mov_b32 v50, 0
    v_mov_b32 v51, 0
    s_getreg_b32 s61, hwreg(HW_REG_XCC_ID, 0, 1)
    s_cmp_eq_u32 s61, 0
    s_cselect_b32 s61, 3, 0
    v_mov_b32 v54, s61
    s_mov_b32 s54, 0
    s_mov_b32 s55, 0
    s_mov_b32 s56, 0
    s_mov_b32 s57, 0
    s_mov_b64 s[82:83], 0
    s_mov_b32 s79, 0
    v_lshlrev_b32 v55, 8, v3
    v_mov_b32 v132, 0
    v_mov_b32 v133, 0
    s_lshl_b32 s58, s30, 8
    s_add_u32 s58, s58, 1967232
    s_mov_b32 s59, 1967232
    s_mov_b32 s60, 1048576
L_ctl:
    ds_read_b64 v[8:9], v59 offset:24
    s_add_u32 s63, s57, 128
    s_lshr_b32 s63, s63, 2
    s_lshl_b32 s63, s63, 10
    s_waitcnt lgkmcnt(0)
    v_add_u32 v46, v8, v9
    v_add_u32 v47, s63, v46
    v_readfirstlane_b32 s61, v46
    v_or_b32 v47, s97, v47
    s_mov_b64 exec, 1
    buffer_store_dword v47, v44, s[48:51], s96 offen
    s_mov_b64 exec, -1
    s_sub_u32 s60, s60, 1
    s_cbranch_scc1 L_end
    s_cmp_ge_u32 s61, 616
    s_cbranch_scc1 L_ctlend
    buffer_load_dword v48, v45, s[48:51], s96 offen sc1
    s_cmp_ge_u32 s61, 584
    s_cselect_b32 s31, 1, s31
    s_cselect_b32 s57, 0, s57
    s_cmp_eq_u32 s31, 0
    s_cbranch_scc0 L_nx1
    buffer_load_dwordx4 v[128:131], v55, s[48:51], s59 offen sc1
L_nx1:
    v_add_u32 v50, v50, v8
    v_add_u32 v51, v51, v9
    s_waitcnt vmcnt(0)
    v_xor_b32 v48, s97, v48
    v_cmp_lt_u32 vcc, 0xffff, v48
    v_readfirstlane_b32 s65, v48
    v_and_b32 v48, 0x3ff, v48
    s_bfe_u32 s65, s65, 0x6000a
    s_lshl_b32 s65, s65, 2
    s_sub_u32 s65, s65, 128
    s_nop 1
    v_add_u32_dpp v48, v48, v48 row_ror:8 row_mask:0xf bank_mask:0xf
    s_nop 1
    v_add_u32_dpp v48, v48, v48 row_ror:4 row_mask:0xf bank_mask:0xf
    s_nop 1
    v_add_u32_dpp v48, v48, v48 row_ror:2 row_mask:0xf bank_mask:0xf
    s_nop 1
    v_add_u32_dpp v48, v48, v48 row_ror:1 row_mask:0xf bank_mask:0xf
    v_mov_b32 v49, v48
    s_nop 1
    v_permlane16_swap_b32 v48, v49
    v_add_u32 v48, v48, v49
    v_lshlrev_b32 v50, 5, v50
    v_lshlrev_b32 v51, 5, v51
    v_sub_u32 v50, v48, v50
    v_sub_u32 v51, v48, v51
    s_or_b32 s62, vcc_lo, s31
    s_cbranch_scc1 L_nx2
    s_mov_b32 s55, s54
    v_readfirstlane_b32 s54, v48
    v_xor_b32 v130, s94, v130
    v_xor_b32 v131, s95, v131
    v_or_b32 v130, v130, v131
    v_cmp_eq_u32 s[62:63], 0, v130
    v_cmp_ne_u32 s[66:67], v128, v132
    s_add_u32 s75, s54, s55
    s_lshr_b32 s75, s75, 1
    s_and_b64 s[66:67], s[66:67], s[62:63]
    v_subrev_u32 v134, s75, v128
    v_cndmask_b32 v133, v133, v134, s[66:67]
    v_cndmask_b32 v132, v132, v128, s[66:67]
    s_and_b64 s[66:67], s[66:67], s[82:83]
    s_or_b64 s[82:83], s[82:83], s[62:63]
    s_or_b32 s79, s79, s66
    v_cmp_ne_u32 s[62:63], s30, v3
    s_nop 1
    v_cndmask_b32 v134, 0, v133, s[62:63]
    s_nop 1
    v_add_u32_dpp v134, v134, v134 quad_perm:[1,0,3,2] row_mask:0xf bank_mask:0xf
    v_add_u32_dpp v129, v129, v129 quad_perm:[1,0,3,2] row_mask:0xf bank_mask:0xf
    s_nop 1
    v_add_u32_dpp v134, v134, v134 quad_perm:[2,3,0,1] row_mask:0xf bank_mask:0xf
    v_add_u32_dpp v129, v129, v129 quad_perm:[2,3,0,1] row_mask:0xf bank_mask:0xf
    s_nop 1
    v_add_u32_dpp v134, v134, v134 row_half_mirror row_mask:0xf bank_mask:0xf
    v_add_u32_dpp v129, v129, v129 row_half_mirror row_mask:0xf bank_mask:0xf
    s_nop 0
    v_readfirstlane_b32 s62, v134
    v_readfirstlane_b32 s63, v129
    s_and_b32 s66, s79, 0xff
    s_cmp_eq_u32 s66, 0xff
    s_cbranch_scc0 L_nx3
    s_mul_i32 s56, s56, 1
    s_add_u32 s56, s56, s62
    s_ashr_i32 s56, s56, 1
    s_ashr_i32 s63, s63, 3
    s_sub_u32 s62, s56, s63
    s_ashr_i32 s62, s62, 3
    s_min_i32 s62, s62, 124
    s_max_i32 s57, s62, -124
L_nx3:
    s_and_b32 s62, s60, 7
    s_cbranch_scc1 L_nx2
    v_mov_b32 v128, s54
    v_mov_b32 v129, s56
    v_mov_b32 v130, s94
    v_mov_b32 v131, s95
    s_mov_b64 exec, 0xff
    buffer_store_dwordx4 v[128:131], v14, s[48:51], s58 offen sc1
    s_mov_b64 exec, -1
L_nx2:
    s_min_i32 s62, s65, 60
    s_max_i32 s62, s62, -60
    s_sub_u32 s62, 36, s62
    s_cmp_eq_u64 vcc, 0
    s_cselect_b32 s62, s62, 0x7fffffff
    s_max_i32 s63, s62, 144
    v_cmp_lt_i32 vcc, s62, v50
    s_nop 1
    v_cndmask_b32 v52, v54, 15, vcc
    v_cmp_lt_i32 vcc, s63, v50
    s_nop 1
    v_cndmask_b32 v52, v52, 31, vcc
    v_cmp_lt_i32 vcc, s62, v51
    s_nop 1
    v_cndmask_b32 v53, v54, 15, vcc
    v_cmp_lt_i32 vcc, s63, v51
    s_nop 1
    v_cndmask_b32 v53, v53, 31, vcc
    ds_write_b64 v59, v[52:53] offset:32
    v_mov_b32 v50, v8
    v_mov_b32 v51, v9
    s_branch L_ctl
L_ctlend:
    s_mov_b32 s60, 1048576
L_waitwl:
    s_sleep 1
    ds_read_b64 v[8:9], v59 offset:24
    s_waitcnt lgkmcnt(0)
    v_add_u32 v8, v8, v9
    s_sub_u32 s60, s60, 1
    v_readfirstlane_b32 s61, v8
    s_cbranch_scc1 L_end
    s_cmp_lt_u32 s61, 626
    s_cbranch_scc1 L_waitwl
    buffer_load_dwordx4 v[64:67], v5, s[40:43], s69 offen nt
    s_addk_i32 s69, 0x2000
    buffer_load_dwordx4 v[68:71], v5, s[40:43], s69 offen nt
    s_addk_i32 s69, 0x2000
    buffer_load_dwordx4 v[72:75], v5, s[40:43], s69 offen nt
    s_addk_i32 s69, 0x2000
    buffer_load_dwordx4 v[76:79], v5, s[40:43], s69 offen nt
    s_addk_i32 s69, 0x2000
    buffer_load_dwordx4 v[80:83], v5, s[40:43], s69 offen nt
    s_addk_i32 s69, 0x2000
    buffer_load_dwordx4 v[84:87], v5, s[40:43], s69 offen nt
    s_addk_i32 s69, 0x2000
    buffer_load_dwordx4 v[88:91], v5, s[40:43], s69 offen nt
    s_addk_i32 s69, 0x2000
    s_mov_b32 s60, 1048576
L_waitown:
    s_sleep 0
    ds_read_b64 v[8:9], v59 offset:24
    s_waitcnt lgkmcnt(0)
    v_add_u32 v8, v8, v9
    s_sub_u32 s60, s60, 1
    v_readfirstlane_b32 s61, v8
    s_cbranch_scc1 L_end
    s_cmp_lt_u32 s61, 634
    s_cbranch_scc1 L_waitown
    s_mov_b32 s60, 262144
    buffer_load_dwordx4 v[44:47], v13, s[48:51], s74 offen sc1
    buffer_load_dwordx4 v[128:131], v15, s[48:51], s84 offen sc1
    buffer_load_dwordx4 v[132:135], v15, s[48:51], s85 offen sc1
    buffer_load_dwordx4 v[136:139], v15, s[48:51], s86 offen sc1
    buffer_load_dwordx4 v[140:143], v15, s[48:51], s87 offen sc1
    buffer_load_dwordx4 v[92:95], v5, s[40:43], s69 offen nt
    s_addk_i32 s69, 0x2000
    buffer_load_dwordx4 v[96:99], v5, s[40:43], s69 offen nt
    s_addk_i32 s69, 0x2000
    buffer_load_dwordx4 v[100:103], v5, s[40:43], s69 offen nt
    s_addk_i32 s69, 0x2000
    buffer_load_dwordx4 v[104:107], v5, s[40:43], s69 offen nt
    s_addk_i32 s69, 0x2000
    buffer_load_dwordx4 v[108:111], v5, s[40:43], s69 offen nt
    s_addk_i32 s69, 0x2000
    buffer_load_dwordx4 v[112:115], v5, s[40:43], s69 offen nt
    s_addk_i32 s69, 0x2000
    buffer_load_dwordx4 v[116:119], v5, s[40:43], s69 offen nt
    s_addk_i32 s69, 0x2000
    buffer_load_dwordx4 v[120:123], v5, s[40:43], s69 offen nt
    s_addk_i32 s69, 0x2000
    buffer_load_dwordx4 v[124:127], v5, s[40:43], s69 offen nt
    s_waitcnt vmcnt(13)
    v_max_f32 v62, v44, v160
    v_xor_b32 v9, s94, v46
    v_xor_b32 v10, s95, v47
    v_max_f32_dpp v62, v62, v62 quad_perm:[1,0,3,2] row_mask:0xf bank_mask:0xf
    v_or_b32 v9, v9, v10
    s_waitcnt vmcnt(12)
    v_xor_b32 v128, s36, v128
    v_max_f32_dpp v62, v62, v62 quad_perm:[2,3,0,1] row_mask:0xf bank_mask:0xf
    v_xor_b32 v129, s37, v129
    v_xor_b32 v130, s38, v130
    v_max_f32_dpp v62, v62, v62 row_half_mirror row_mask:0xf bank_mask:0xf
    v_xor_b32 v131, s39, v131
    v_or3_b32 v8, v128, v129, v130
    v_or_b32 v8, v8, v131
    s_waitcnt vmcnt(11)
    v_xor_b32 v132, s36, v132
    v_sub_f32 v63, v44, v62
    v_xor_b32 v133, s37, v133
    v_xor_b32 v134, s38, v134
    v_exp_f32 v63, v63
    v_xor_b32 v135, s39, v135
    v_or3_b32 v8, v8, v132, v133
    v_or3_b32 v8, v8, v134, v135
    s_waitcnt vmcnt(10)
    v_xor_b32 v136, s36, v136
    v_xor_b32 v137, s37, v137
    v_xor_b32 v138, s38, v138
    v_xor_b32 v139, s39, v139
    v_or3_b32 v8, v8, v136, v137
    v_or3_b32 v8, v8, v138, v139
    s_waitcnt vmcnt(9)
    v_xor_b32 v140, s36, v140
    v_xor_b32 v141, s37, v141
    v_xor_b32 v142, s38, v142
    v_xor_b32 v143, s39, v143
    v_or3_b32 v8, v8, v140, v141
    v_or3_b32 v8, v8, v142, v143
    v_and_or_b32 v8, v8, v60, v9
    v_cmp_ne_u32 vcc, 0, v8
    s_cbranch_vccz L_gok
L_fin:
    s_mov_b32 s60, 262144
L_g0:
    buffer_load_dwordx4 v[44:47], v13, s[48:51], s74 offen sc1
    buffer_load_dwordx4 v[128:131], v15, s[48:51], s84 offen sc1
    buffer_load_dwordx4 v[132:135], v15, s[48:51], s85 offen sc1
    buffer_load_dwordx4 v[136:139], v15, s[48:51], s86 offen sc1
    buffer_load_dwordx4 v[140:143], v15, s[48:51], s87 offen sc1
    s_sub_u32 s60, s60, 1
    s_cbranch_scc1 L_end
    s_waitcnt vmcnt(4)
    v_max_f32 v62, v44, v160
    v_xor_b32 v9, s94, v46
    v_xor_b32 v10, s95, v47
    v_max_f32_dpp v62, v62, v62 quad_perm:[1,0,3,2] row_mask:0xf bank_mask:0xf
    v_or_b32 v9, v9, v10
    s_waitcnt vmcnt(3)
    v_xor_b32 v128, s36, v128
    v_max_f32_dpp v62, v62, v62 quad_perm:[2,3,0,1] row_mask:0xf bank_mask:0xf
    v_xor_b32 v129, s37, v129
    v_xor_b32 v130, s38, v130
    v_max_f32_dpp v62, v62, v62 row_half_mirror row_mask:0xf bank_mask:0xf
    v_xor_b32 v131, s39, v131
    v_or3_b32 v8, v128, v129, v130
    v_or_b32 v8, v8, v131
    s_waitcnt vmcnt(2)
    v_xor_b32 v132, s36, v132
    v_sub_f32 v63, v44, v62
    v_xor_b32 v133, s37, v133
    v_xor_b32 v134, s38, v134
    v_exp_f32 v63, v63
    v_xor_b32 v135, s39, v135
    v_or3_b32 v8, v8, v132, v133
    v_or3_b32 v8, v8, v134, v135
    s_waitcnt vmcnt(1)
    v_xor_b32 v136, s36, v136
    v_xor_b32 v137, s37, v137
    v_xor_b32 v138, s38, v138
    v_xor_b32 v139, s39, v139
    v_or3_b32 v8, v8, v136, v137
    v_or3_b32 v8, v8, v138, v139
    s_waitcnt vmcnt(0)
    v_xor_b32 v140, s36, v140
    v_xor_b32 v141, s37, v141
    v_xor_b32 v142, s38, v142
    v_xor_b32 v143, s39, v143
    v_or3_b32 v8, v8, v140, v141
    v_or3_b32 v8, v8, v142, v143
    v_and_or_b32 v8, v8, v60, v9
    v_cmp_ne_u32 vcc, 0, v8
    s_cbranch_vccnz L_g0
L_gok:
    v_mul_f32_dpp v48, v63, v128 row_newbcast:0 row_mask:0xf bank_mask:0xf
    v_mul_f32_dpp v49, v63, v129 row_newbcast:0 row_mask:0xf bank_mask:0xf
    v_mul_f32_dpp v50, v63, v130 row_newbcast:0 row_mask:0xf bank_mask:0xf
    v_mul_f32_dpp v51, v63, v131 row_newbcast:0 row_mask:0xf bank_mask:0xf
    v_mul_f32_dpp v52, v63, v136 row_newbcast:8 row_mask:0xf bank_mask:0xf
    v_mul_f32_dpp v53, v63, v137 row_newbcast:8 row_mask:0xf bank_mask:0xf
    v_mul_f32_dpp v54, v63, v138 row_newbcast:8 row_mask:0xf bank_mask:0xf
    v_mul_f32_dpp v55, v63, v139 row_newbcast:8 row_mask:0xf bank_mask:0xf
    v_fmac_f32_dpp v48, v63, v132 row_newbcast:4 row_mask:0xf bank_mask:0xf
    v_fmac_f32_dpp v49, v63, v133 row_newbcast:4 row_mask:0xf bank_mask:0xf
    v_fmac_f32_dpp v50, v63, v134 row_newbcast:4 row_mask:0xf bank_mask:0xf
    v_fmac_f32_dpp v51, v63, v135 row_newbcast:4 row_mask:0xf bank_mask:0xf
    v_fmac_f32_dpp v52, v63, v140 row_newbcast:12 row_mask:0xf bank_mask:0xf
    v_fmac_f32_dpp v53, v63, v141 row_newbcast:12 row_mask:0xf bank_mask:0xf
    v_fmac_f32_dpp v54, v63, v142 row_newbcast:12 row_mask:0xf bank_mask:0xf
    v_fmac_f32_dpp v55, v63, v143 row_newbcast:12 row_mask:0xf bank_mask:0xf
    v_mul_f32 v61, v45, v63
    s_cmp_eq_u32 s64, 0
    s_cbranch_scc1 L_m3
    v_sub_f32 v56, v160, v62
    v_exp_f32 v56, v56
    s_nop 0
    v_fmac_f32 v61, v161, v56
    s_nop 0
    v_fmac_f32_dpp v48, v56, v144 row_newbcast:0 row_mask:0xf bank_mask:0xf
    v_fmac_f32_dpp v49, v56, v145 row_newbcast:0 row_mask:0xf bank_mask:0xf
    v_fmac_f32_dpp v50, v56, v146 row_newbcast:0 row_mask:0xf bank_mask:0xf
    v_fmac_f32_dpp v51, v56, v147 row_newbcast:0 row_mask:0xf bank_mask:0xf
    v_fmac_f32_dpp v52, v56, v152 row_newbcast:8 row_mask:0xf bank_mask:0xf
    v_fmac_f32_dpp v53, v56, v153 row_newbcast:8 row_mask:0xf bank_mask:0xf
    v_fmac_f32_dpp v54, v56, v154 row_newbcast:8 row_mask:0xf bank_mask:0xf
    v_fmac_f32_dpp v55, v56, v155 row_newbcast:8 row_mask:0xf bank_mask:0xf
    v_fmac_f32_dpp v48, v56, v148 row_newbcast:4 row_mask:0xf bank_mask:0xf
    v_fmac_f32_dpp v49, v56, v149 row_newbcast:4 row_mask:0xf bank_mask:0xf
    v_fmac_f32_dpp v50, v56, v150 row_newbcast:4 row_mask:0xf bank_mask:0xf
    v_fmac_f32_dpp v51, v56, v151 row_newbcast:4 row_mask:0xf bank_mask:0xf
    v_fmac_f32_dpp v52, v56, v156 row_newbcast:12 row_mask:0xf bank_mask:0xf
    v_fmac_f32_dpp v53, v56, v157 row_newbcast:12 row_mask:0xf bank_mask:0xf
    v_fmac_f32_dpp v54, v56, v158 row_newbcast:12 row_mask:0xf bank_mask:0xf
    v_fmac_f32_dpp v55, v56, v159 row_newbcast:12 row_mask:0xf bank_mask:0xf
L_m3:
    v_permlane32_swap_b32 v48, v52
    v_permlane32_swap_b32 v49, v53
    v_permlane32_swap_b32 v50, v54
    v_permlane32_swap_b32 v51, v55
    v_add_f32 v48, v48, v52
    v_add_f32 v49, v49, v53
    v_add_f32 v50, v50, v54
    v_add_f32 v51, v51, v55
    v_add_f32_dpp v61, v61, v61 quad_perm:[1,0,3,2] row_mask:0xf bank_mask:0xf
    v_permlane16_swap_b32 v48, v50
    v_permlane16_swap_b32 v49, v51
    v_add_f32 v48, v48, v50
    v_add_f32 v49, v49, v51
    v_cvt_pk_bf16_f32 v8, v48, v49
    ds_write_b32 v57, v8
    ds_read_b128 v[16:19], v58
    ds_read_b128 v[20:23], v58 offset:16
    v_add_f32_dpp v61, v61, v61 quad_perm:[2,3,0,1] row_mask:0xf bank_mask:0xf
    s_nop 1
    v_add_f32_dpp v61, v61, v61 row_half_mirror row_mask:0xf bank_mask:0xf
    v_rcp_f32 v61, v61
    s_waitcnt lgkmcnt(0)
    s_cbranch_scc1 L_projmm
    s_mov_b32 s60, 1048576
L_waityb:
    s_sleep 1
    ds_read_b64 v[8:9], v59 offset:24
    s_waitcnt lgkmcnt(0)
    v_add_u32 v8, v8, v9
    s_sub_u32 s60, s60, 1
    v_readfirstlane_b32 s61, v8
    s_cbranch_scc1 L_end
    s_cmp_lt_u32 s61, 628
    s_cbranch_scc1 L_waityb
    s_mov_b32 s60, s69
    buffer_load_dwordx4 v[64:67], v5, s[40:43], s60 offen nt
    s_addk_i32 s60, 0x2000
    buffer_load_dwordx4 v[68:71], v5, s[40:43], s60 offen nt
    s_addk_i32 s60, 0x2000
    buffer_load_dwordx4 v[72:75], v5, s[40:43], s60 offen nt
    s_addk_i32 s60, 0x2000
    buffer_load_dwordx4 v[76:79], v5, s[40:43], s60 offen nt
    s_addk_i32 s60, 0x2000
    buffer_load_dwordx4 v[80:83], v5, s[40:43], s60 offen nt
    s_addk_i32 s60, 0x2000
    buffer_load_dwordx4 v[84:87], v5, s[40:43], s60 offen nt
    s_addk_i32 s60, 0x2000
    buffer_load_dwordx4 v[88:91], v5, s[40:43], s60 offen nt
    s_addk_i32 s60, 0x2000
    buffer_load_dwordx4 v[92:95], v5, s[40:43], s60 offen nt
    s_addk_i32 s60, 0x2000
    buffer_load_dwordx4 v[96:99], v5, s[40:43], s60 offen nt
    s_addk_i32 s60, 0x2000
    buffer_load_dwordx4 v[100:103], v5, s[40:43], s60 offen nt
    s_addk_i32 s60, 0x2000
    buffer_load_dwordx4 v[104:107], v5, s[40:43], s60 offen nt
    s_addk_i32 s60, 0x2000
    buffer_load_dwordx4 v[108:111], v5, s[40:43], s60 offen nt
    s_addk_i32 s60, 0x2000
    s_waitcnt vmcnt(11)
    buffer_load_dwordx4 v[112:115], v5, s[40:43], s60 offen nt
    s_addk_i32 s60, 0x2000
    s_waitcnt vmcnt(11)
    buffer_load_dwordx4 v[116:119], v5, s[40:43], s60 offen nt
    s_addk_i32 s60, 0x2000
    s_waitcnt vmcnt(11)
    buffer_load_dwordx4 v[120:123], v5, s[40:43], s60 offen nt
    s_addk_i32 s60, 0x2000
    s_waitcnt vmcnt(11)
    buffer_load_dwordx4 v[124:127], v5, s[40:43], s60 offen nt
    s_waitcnt vmcnt(9)
    s_branch L_projmm
L_ret_fin:
    s_cmp_eq_u32 s64, 0
    s_cbranch_scc0 L_yw1
    v_mov_b32 v8, 1
    ds_write_b32 v59, v8 offset:20
    s_cmp_lg_u32 s81, 0
    s_cbranch_scc1 L_done
    s_branch L_yw2
L_yw1:
    s_cmp_lg_u32 s81, 0
    s_cbranch_scc1 L_done
    s_mov_b32 s60, 1048576
L_yw:
    s_sleep 1
    ds_read_b32 v8, v59 offset:20
    s_waitcnt lgkmcnt(0)
    v_readfirstlane_b32 s61, v8
    s_sub_u32 s60, s60, 1
    s_cbranch_scc1 L_end
    s_cmp_lt_u32 s61, 1
    s_cbranch_scc1 L_yw
L_yw2:
    buffer_load_dwordx4 v[64:67], v12, s[48:51], s80 offen sc1
    s_add_u32 s61, s80, 245760
    buffer_load_dwordx4 v[68:71], v12, s[48:51], s61 offen sc1
    s_add_u32 s61, s80, 491520
    buffer_load_dwordx4 v[72:75], v12, s[48:51], s61 offen sc1
    s_add_u32 s61, s80, 737280
    buffer_load_dwordx4 v[76:79], v12, s[48:51], s61 offen sc1
    s_add_u32 s61, s80, 983040
    buffer_load_dwordx4 v[80:83], v12, s[48:51], s61 offen sc1
    s_add_u32 s61, s80, 1228800
    buffer_load_dwordx4 v[84:87], v12, s[48:51], s61 offen sc1
    s_add_u32 s61, s80, 1474560
    buffer_load_dwordx4 v[88:91], v12, s[48:51], s61 offen sc1
    s_add_u32 s61, s80, 1720320
    buffer_load_dwordx4 v[92:95], v12, s[48:51], s61 offen sc1
    s_sleep 7
    buffer_load_dwordx4 v[96:99], v12, s[48:51], s80 offen sc1
    s_add_u32 s61, s80, 245760
    buffer_load_dwordx4 v[100:103], v12, s[48:51], s61 offen sc1
    s_add_u32 s61, s80, 491520
    buffer_load_dwordx4 v[104:107], v12, s[48:51], s61 offen sc1
    s_add_u32 s61, s80, 737280
    buffer_load_dwordx4 v[108:111], v12, s[48:51], s61 offen sc1
    s_add_u32 s61, s80, 983040
    buffer_load_dwordx4 v[112:115], v12, s[48:51], s61 offen sc1
    s_add_u32 s61, s80, 1228800
    buffer_load_dwordx4 v[116:119], v12, s[48:51], s61 offen sc1
    s_add_u32 s61, s80, 1474560
    buffer_load_dwordx4 v[120:123], v12, s[48:51], s61 offen sc1
    s_add_u32 s61, s80, 1720320
    buffer_load_dwordx4 v[124:127], v12, s[48:51], s61 offen sc1
L_y:
    s_waitcnt vmcnt(15)
    v_xor_b32 v64, s36, v64
    v_xor_b32 v65, s37, v65
    v_xor_b32 v66, s38, v66
    v_xor_b32 v67, s39, v67
    v_or3_b32 v8, v64, v65, v66
    v_or_b32 v8, v8, v67
    s_waitcnt vmcnt(14)
    v_xor_b32 v68, s36, v68
    v_xor_b32 v69, s37, v69
    v_xor_b32 v70, s38, v70
    v_xor_b32 v71, s39, v71
    v_or3_b32 v8, v8, v68, v69
    v_or3_b32 v8, v8, v70, v71
    v_add_f32 v48, v64, v68
    v_add_f32 v49, v65, v69
    v_add_f32 v50, v66, v70
    v_add_f32 v51, v67, v71
    s_waitcnt vmcnt(13)
    v_xor_b32 v72, s36, v72
    v_xor_b32 v73, s37, v73
    v_xor_b32 v74, s38, v74
    v_xor_b32 v75, s39, v75
    v_or3_b32 v8, v8, v72, v73
    v_or3_b32 v8, v8, v74, v75
    v_add_f32 v48, v48, v72
    v_add_f32 v49, v49, v73
    v_add_f32 v50, v50, v74
    v_add_f32 v51, v51, v75
    s_waitcnt vmcnt(12)
    v_xor_b32 v76, s36, v76
    v_xor_b32 v77, s37, v77
    v_xor_b32 v78, s38, v78
    v_xor_b32 v79, s39, v79
    v_or3_b32 v8, v8, v76, v77
    v_or3_b32 v8, v8, v78, v79
    v_add_f32 v48, v48, v76
    v_add_f32 v49, v49, v77
    v_add_f32 v50, v50, v78
    v_add_f32 v51, v51, v79
    s_waitcnt vmcnt(11)
    v_xor_b32 v80, s36, v80
    v_xor_b32 v81, s37, v81
    v_xor_b32 v82, s38, v82
    v_xor_b32 v83, s39, v83
    v_or3_b32 v8, v8, v80, v81
    v_or3_b32 v8, v8, v82, v83
    v_add_f32 v48, v48, v80
    v_add_f32 v49, v49, v81
    v_add_f32 v50, v50, v82
    v_add_f32 v51, v51, v83
    s_waitcnt vmcnt(10)
    v_xor_b32 v84, s36, v84
    v_xor_b32 v85, s37, v85
    v_xor_b32 v86, s38, v86
    v_xor_b32 v87, s39, v87
    v_or3_b32 v8, v8, v84, v85
    v_or3_b32 v8, v8, v86, v87
    v_add_f32 v48, v48, v84
    v_add_f32 v49, v49, v85
    v_add_f32 v50, v50, v86
    v_add_f32 v51, v51, v87
    s_waitcnt vmcnt(9)
    v_xor_b32 v88, s36, v88
    v_xor_b32 v89, s37, v89
    v_xor_b32 v90, s38, v90
    v_xor_b32 v91, s39, v91
    v_or3_b32 v8, v8, v88, v89
    v_or3_b32 v8, v8, v90, v91
    v_add_f32 v48, v48, v88
    v_add_f32 v49, v49, v89
    v_add_f32 v50, v50, v90
    v_add_f32 v51, v51, v91
    s_waitcnt vmcnt(8)
    v_xor_b32 v92, s36, v92
    v_xor_b32 v93, s37, v93
    v_xor_b32 v94, s38, v94
    v_xor_b32 v95, s39, v95
    v_or3_b32 v8, v8, v92, v93
    v_or3_b32 v8, v8, v94, v95
    v_add_f32 v48, v48, v92
    v_add_f32 v49, v49, v93
    v_add_f32 v50, v50, v94
    v_add_f32 v51, v51, v95
    v_and_b32 v8, 0xff, v8
    v_cmp_ne_u32 vcc, 0, v8
    s_cbranch_vccz L_yok
    buffer_load_dwordx4 v[64:67], v12, s[48:51], s80 offen sc1
    s_add_u32 s61, s80, 245760
    buffer_load_dwordx4 v[68:71], v12, s[48:51], s61 offen sc1
    s_add_u32 s61, s80, 491520
    buffer_load_dwordx4 v[72:75], v12, s[48:51], s61 offen sc1
    s_add_u32 s61, s80, 737280
    buffer_load_dwordx4 v[76:79], v12, s[48:51], s61 offen sc1
    s_add_u32 s61, s80, 983040
    buffer_load_dwordx4 v[80:83], v12, s[48:51], s61 offen sc1
    s_add_u32 s61, s80, 1228800
    buffer_load_dwordx4 v[84:87], v12, s[48:51], s61 offen sc1
    s_add_u32 s61, s80, 1474560
    buffer_load_dwordx4 v[88:91], v12, s[48:51], s61 offen sc1
    s_add_u32 s61, s80, 1720320
    buffer_load_dwordx4 v[92:95], v12, s[48:51], s61 offen sc1
    s_waitcnt vmcnt(15)
    v_xor_b32 v96, s36, v96
    v_xor_b32 v97, s37, v97
    v_xor_b32 v98, s38, v98
    v_xor_b32 v99, s39, v99
    v_or3_b32 v8, v96, v97, v98
    v_or_b32 v8, v8, v99
    s_waitcnt vmcnt(14)
    v_xor_b32 v100, s36, v100
    v_xor_b32 v101, s37, v101
    v_xor_b32 v102, s38, v102
    v_xor_b32 v103, s39, v103
    v_or3_b32 v8, v8, v100, v101
    v_or3_b32 v8, v8, v102, v103
    v_add_f32 v48, v96, v100
    v_add_f32 v49, v97, v101
    v_add_f32 v50, v98, v102
    v_add_f32 v51, v99, v103
    s_waitcnt vmcnt(13)
    v_xor_b32 v104, s36, v104
    v_xor_b32 v105, s37, v105
    v_xor_b32 v106, s38, v106
    v_xor_b32 v107, s39, v107
    v_or3_b32 v8, v8, v104, v105
    v_or3_b32 v8, v8, v106, v107
    v_add_f32 v48, v48, v104
    v_add_f32 v49, v49, v105
    v_add_f32 v50, v50, v106
    v_add_f32 v51, v51, v107
    s_waitcnt vmcnt(12)
    v_xor_b32 v108, s36, v108
    v_xor_b32 v109, s37, v109
    v_xor_b32 v110, s38, v110
    v_xor_b32 v111, s39, v111
    v_or3_b32 v8, v8, v108, v109
    v_or3_b32 v8, v8, v110, v111
    v_add_f32 v48, v48, v108
    v_add_f32 v49, v49, v109
    v_add_f32 v50, v50, v110
    v_add_f32 v51, v51, v111
    s_waitcnt vmcnt(11)
    v_xor_b32 v112, s36, v112
    v_xor_b32 v113, s37, v113
    v_xor_b32 v114, s38, v114
    v_xor_b32 v115, s39, v115
    v_or3_b32 v8, v8, v112, v113
    v_or3_b32 v8, v8, v114, v115
    v_add_f32 v48, v48, v112
    v_add_f32 v49, v49, v113
    v_add_f32 v50, v50, v114
    v_add_f32 v51, v51, v115
    s_waitcnt vmcnt(10)
    v_xor_b32 v116, s36, v116
    v_xor_b32 v117, s37, v117
    v_xor_b32 v118, s38, v118
    v_xor_b32 v119, s39, v119
    v_or3_b32 v8, v8, v116, v117
    v_or3_b32 v8, v8, v118, v119
    v_add_f32 v48, v48, v116
    v_add_f32 v49, v49, v117
    v_add_f32 v50, v50, v118
    v_add_f32 v51, v51, v119
    s_waitcnt vmcnt(9)
    v_xor_b32 v120, s36, v120
    v_xor_b32 v121, s37, v121
    v_xor_b32 v122, s38, v122
    v_xor_b32 v123, s39, v123
    v_or3_b32 v8, v8, v120, v121
    v_or3_b32 v8, v8, v122, v123
    v_add_f32 v48, v48, v120
    v_add_f32 v49, v49, v121
    v_add_f32 v50, v50, v122
    v_add_f32 v51, v51, v123
    s_waitcnt vmcnt(8)
    v_xor_b32 v124, s36, v124
    v_xor_b32 v125, s37, v125
    v_xor_b32 v126, s38, v126
    v_xor_b32 v127, s39, v127
    v_or3_b32 v8, v8, v124, v125
    v_or3_b32 v8, v8, v126, v127
    v_add_f32 v48, v48, v124
    v_add_f32 v49, v49, v125
    v_add_f32 v50, v50, v126
    v_add_f32 v51, v51, v127
    v_and_b32 v8, 0xff, v8
    v_cmp_ne_u32 vcc, 0, v8
    s_cbranch_vccz L_yok
    buffer_load_dwordx4 v[96:99], v12, s[48:51], s80 offen sc1
    s_add_u32 s61, s80, 245760
    buffer_load_dwordx4 v[100:103], v12, s[48:51], s61 offen sc1
    s_add_u32 s61, s80, 491520
    buffer_load_dwordx4 v[104:107], v12, s[48:51], s61 offen sc1
    s_add_u32 s61, s80, 737280
    buffer_load_dwordx4 v[108:111], v12, s[48:51], s61 offen sc1
    s_add_u32 s61, s80, 983040
    buffer_load_dwordx4 v[112:115], v12, s[48:51], s61 offen sc1
    s_add_u32 s61, s80, 1228800
    buffer_load_dwordx4 v[116:119], v12, s[48:51], s61 offen sc1
    s_add_u32 s61, s80, 1474560
    buffer_load_dwordx4 v[120:123], v12, s[48:51], s61 offen sc1
    s_add_u32 s61, s80, 1720320
    buffer_load_dwordx4 v[124:127], v12, s[48:51], s61 offen sc1
    s_sub_u32 s60, s60, 1
    s_cbranch_scc0 L_y
    s_endpgm
L_yok:
    v_permlane32_swap_b32 v48, v49
    v_permlane32_swap_b32 v50, v51
    v_add_f32 v48, v48, v49
    v_add_f32 v50, v50, v51
    s_nop 1
    v_permlane16_swap_b32 v48, v50
    v_add_f32 v8, v48, v50
    s_nop 1
    v_add_f32_dpp v8, v8, v8 row_ror:8 row_mask:0xf bank_mask:0xf
    v_cvt_pk_bf16_f32 v8, v8, v8
    s_mov_b32 exec_lo, 0x00ff00ff
    s_mov_b32 exec_hi, 0x00ff00ff
    buffer_store_short v8, v11, s[44:47], s77 offen
    s_or_b32 s60, s2, s64
    s_cbranch_scc1 L_done
    s_mov_b64 exec, 0xffffffff
    v_mov_b32 v9, s94
    v_lshlrev_b32 v10, 2, v0
    buffer_store_dword v9, v10, s[48:51], 0 offen
L_done:
L_end:
    s_endpgm
.section .rodata,"a"
.p2align 6
.amdhsa_kernel concat_heads__mha_block_cached__gqa_block_cached__decode_kernel
  .amdhsa_next_free_vgpr 168
  .amdhsa_next_free_sgpr 99
  .amdhsa_accum_offset 168
  .amdhsa_group_segment_fixed_size 0
  .amdhsa_kernarg_size 104
  .amdhsa_user_sgpr_count 2
  .amdhsa_user_sgpr_kernarg_segment_ptr 1
  .amdhsa_system_sgpr_workgroup_id_x 1
.end_amdhsa_kernel
```
